```python
import torch

def _softmax(x, axis=-1):
    return torch.softmax(x, dim=axis)

def _gelu(x):
    return torch.nn.functional.gelu(x, approximate='tanh')

def _silu(x):
    return torch.nn.functional.silu(x)

def _sigmoid(x):
    return torch.sigmoid(x)

def _layernorm(x, axis=-1, eps=1e-05):
    m = x.mean(dim=axis, keepdim=True)
    v = x.var(dim=axis, keepdim=True, unbiased=False)
    return (x - m) / torch.sqrt(v + eps)

def _scatter_add(tgt, idx, src, axis=0):
    return tgt.clone().index_add_(axis, idx, src)

def _segment_sum(src, seg, n):
    out = torch.zeros((n,) + src.shape[1:], dtype=src.dtype)
    return out.index_add_(0, seg, src)

def _pad(x, pw):
    flat = tuple((v for pair in reversed(pw) for v in pair))
    return torch.nn.functional.pad(x, flat)
kernel_name = 'adaLN_cond__sliding_block_cached__dense_activation_squared_relu__prompt'

def setup_inputs():

    _w = lambda a: (lambda t: t.to(torch.bfloat16) if t.is_floating_point() else t)(torch.as_tensor(a))

    def _A_setup():
        B, Sq, D = (1, 2048, 512)
        Hq, Hkv, Sk, Dh = (32, 8, 2048, 128)
        assert Hq % Hkv == 0, (Hq, Hkv)
        return {'x': _w((lambda *s: torch.randn(*s, dtype=torch.bfloat16) * 0.05)(B, Sq, D)), 'k_cache': _w((lambda *s: torch.randn(*s, dtype=torch.bfloat16) * 3.2)(B, Hkv, Sk, Dh)), 'v_cache': _w((lambda *s: torch.randn(*s, dtype=torch.bfloat16) * 0.4)(B, Hkv, Sk, Dh)), 'wq': _w((lambda *s: torch.randn(*s, dtype=torch.bfloat16) * 3.2)(D, Hq * Dh) * D ** (-0.5)), 'wo': _w((lambda *s: torch.randn(*s, dtype=torch.bfloat16) * 0.4)(Hq * Dh, D) * (Hq * Dh) ** (-0.5))}
    _A_in = _A_setup()

    def _B_setup():
        B, S, D, F = (1, 2048, 512, 1792)
        return {'x': _w((lambda *s: torch.randn(*s, dtype=torch.bfloat16) * 0.05)(B, S, D)), 'w1': _w((lambda *s: torch.randn(*s, dtype=torch.bfloat16) * 0.05)(D, F)), 'b1': _w((lambda *s: torch.randn(*s, dtype=torch.bfloat16) * 0.4)(F)), 'w2': _w((lambda *s: torch.randn(*s, dtype=torch.bfloat16) * 0.05)(F, D)), 'b2': _w((lambda *s: torch.randn(*s, dtype=torch.bfloat16) * 6.4)(D))}
    _B_in = _B_setup()
    return {'A_x': _A_in['x'], 'A_k_cache': _A_in['k_cache'], 'A_v_cache': _A_in['v_cache'], 'A_wq': _A_in['wq'], 'A_wo': _A_in['wo'], 'B_x': _B_in['x'], 'B_w1': _B_in['w1'], 'B_b1': _B_in['b1'], 'B_w2': _B_in['w2'], 'B_b2': _B_in['b2'], 'c': _w((lambda *s: torch.randn(*s, dtype=torch.bfloat16) * 0.1)(1, 512) * 8.0), 'w_mod': _w((lambda *s: torch.randn(*s, dtype=torch.bfloat16) * 0.1)(512, 6 * 512) * 512 ** (-0.5) * 8.0)}

def reference(A_x, A_k_cache, A_v_cache, A_wq, A_wo, B_x, B_w1, B_b1, B_w2, B_b2, c, w_mod):

    def _A_ref(x, k_cache, v_cache, wq, wo):
        B, Sq, D = x.shape
        Hq, Dh = (32, 128)
        Hkv, Sk = (k_cache.shape[1], k_cache.shape[2])
        W = min(4096, max(256, Sk // 4))
        rep = Hq // Hkv
        q = (lambda x, *d: x.permute(*d))((x @ wq).reshape(B, Sq, Hq, Dh), 0, 2, 1, 3)
        k = (lambda x, n, axis: torch.repeat_interleave(x, n, dim=axis))(k_cache[:, :, Sk - W:, :], rep, axis=1)
        v = (lambda x, n, axis: torch.repeat_interleave(x, n, dim=axis))(v_cache[:, :, Sk - W:, :], rep, axis=1)
        scores = torch.einsum('bhqd,bhkd->bhqk', q, k) * Dh ** (-0.5)
        p = _softmax(scores, axis=-1)
        o = torch.einsum('bhqk,bhkd->bhqd', p, v)
        return (lambda x, *d: x.permute(*d))(o, 0, 2, 1, 3).reshape(B, Sq, Hq * Dh) @ wo

    def _B_ref(x, w1, b1, w2, b2):
        h = torch.einsum('bsd,df->bsf', x, w1) + b1
        zero = torch.zeros_like(h)
        r = torch.where(h > zero, h, zero)
        h = r * r
        out = torch.einsum('bsf,fd->bsd', h, w2) + b2
        return out
    x = A_x
    mod = (_silu(c) @ w_mod).reshape(c.shape[0], 6, 1, -1)
    sa, ca, ga, sb, cb, gb = (mod[:, 0].clone(), mod[:, 1].clone(), mod[:, 2].clone(), mod[:, 3].clone(), mod[:, 4].clone(), mod[:, 5].clone())
    h = _layernorm(x, axis=-1) * (1 + ca) + sa
    x = x + ga * _A_ref(h, A_k_cache, A_v_cache, A_wq, A_wo)
    h = _layernorm(x, axis=-1) * (1 + cb) + sb
    x = x + gb * _B_ref(h, B_w1, B_b1, B_w2, B_b2)
    return x
```

```asm
; @launch grid=(256,1,1) block=(512,1,1) lds=163840
.amdgcn_target "amdgcn-amd-amdhsa--gfx950"
.text
.globl adaLN_cond__sliding_block_cached__dense_activation_squared_relu__prompt_kernel
.p2align 8
.type adaLN_cond__sliding_block_cached__dense_activation_squared_relu__prompt_kernel,@function
adaLN_cond__sliding_block_cached__dense_activation_squared_relu__prompt_kernel:
    s_cmp_ge_u32 s2, 256
    s_cbranch_scc1 K_end
    s_load_dwordx8 s[4:11], s[0:1], 0
    s_load_dwordx16 s[12:27], s[0:1], 32
    s_load_dwordx4 s[28:31], s[0:1], 96
    s_load_dwordx2 s[32:33], s[0:1], 112
    v_mov_b32 v60, v0
    v_lshrrev_b32 v22, 6, v0
    v_and_b32 v0, 63, v0
    s_mov_b32 s67, 0xffff0000
    v_readfirstlane_b32 s64, v22
    v_lshlrev_b32 v21, 4, v0
    s_and_b32 s65, s2, 7
    s_lshr_b32 s66, s2, 6
    s_lshl_b32 s66, s66, 3
    s_add_u32 s65, s65, s66
    s_lshr_b32 s66, s2, 3
    s_and_b32 s66, s66, 7
    s_lshr_b32 s76, s2, 4
    s_lshl_b32 s76, s76, 4
    s_and_b32 s71, s2, 7
    s_lshl_b32 s71, s71, 1
    s_add_u32 s76, s76, s71
    s_lshr_b32 s71, s2, 3
    s_and_b32 s71, s71, 1
    s_add_u32 s76, s76, s71
    s_lshl_b32 s71, s76, 6
    v_lshrrev_b32 v22, 2, v60
    v_and_b32 v23, 3, v60
    v_mul_u32_u24 v61, 24576, v22
    v_lshl_add_u32 v61, v23, 4, v61
    v_add_u32 v61, s71, v61
    v_lshlrev_b32 v62, 3, v22
    s_lshl_b32 s68, s64, 11
    s_mul_i32 s69, s64, 12288
    s_mul_i32 s70, s66, 1024
    s_lshl_b32 s71, s64, 7
    s_add_u32 s70, s70, s71
    s_lshl_b32 s77, s65, 16
    s_lshl_b32 s71, s64, 13
    s_add_u32 s77, s77, s71
    s_add_u32 s78, s77, 4096
    s_lshl_b32 s35, s65, 10
    s_add_u32 s35, s35, 32768
    v_min_u32 v39, 1, v0
    v_lshlrev_b32 v39, 20, v39
    s_waitcnt lgkmcnt(0)
    s_mov_b32 s60, s32
    s_mov_b32 s61, s33
    s_mov_b32 s62, 65536
    s_mov_b32 s63, 0x00020000
    s_mov_b32 s56, s30
    s_mov_b32 s57, s31
    s_mov_b32 s58, 256
    s_mov_b32 s59, 0x00020000
    v_mov_b32 v221, 0x100000
    v_mov_b32 v58, 0x100000
    v_lshlrev_b32 v59, 10, v0
    v_add_u32 v59, 32768, v59
    v_cmp_gt_u32 vcc, 32, v60
    s_nop 1
    v_cndmask_b32 v59, v221, v59, vcc
    buffer_load_dword v63, v59, s[60:63], 0 offen sc1
    s_cmp_lt_u32 s2, 0
    s_cbranch_scc1 K_ngaL
    s_cmp_ge_u32 s2, 32
    s_cbranch_scc1 K_ngaL
    s_cmp_lg_u32 s64, 0
    s_cbranch_scc1 K_x0
    s_mov_b32 s48, s4
    s_mov_b32 s49, s5
    s_mov_b32 s50, 2097152
    s_mov_b32 s51, 0x00020000
    buffer_load_dwordx4 v[64:67], v21, s[48:51], s77 offen offset:0
    buffer_load_dwordx4 v[68:71], v21, s[48:51], s77 offen offset:1024
    buffer_load_dwordx4 v[72:75], v21, s[48:51], s77 offen offset:2048
    buffer_load_dwordx4 v[76:79], v21, s[48:51], s77 offen offset:3072
    buffer_load_dwordx4 v[80:83], v21, s[48:51], s78 offen offset:0
    buffer_load_dwordx4 v[84:87], v21, s[48:51], s78 offen offset:1024
    buffer_load_dwordx4 v[88:91], v21, s[48:51], s78 offen offset:2048
    buffer_load_dwordx4 v[92:95], v21, s[48:51], s78 offen offset:3072
K_x0:
    s_mov_b32 s79, 6144
    s_mov_b32 s80, 12288
    s_mov_b32 s81, 18432
    s_mov_b32 s48, s24
    s_mov_b32 s49, s25
    s_mov_b32 s50, 1024
    s_mov_b32 s51, 0x00020000
    s_mov_b32 s52, s26
    s_mov_b32 s53, s27
    s_mov_b32 s54, 3145728
    s_mov_b32 s55, 0x00020000
    buffer_load_dwordx2 v[208:209], v62, s[48:51], 0 offen
    buffer_load_dwordx4 v[192:195], v61, s[52:55], 0 offen
    buffer_load_dwordx4 v[196:199], v61, s[52:55], s79 offen
    buffer_load_dwordx4 v[200:203], v61, s[52:55], s80 offen
    buffer_load_dwordx4 v[204:207], v61, s[52:55], s81 offen
    v_min_u32 v220, 11, v0
    v_lshlrev_b32 v220, 4, v220
    s_lshl_b32 s71, s76, 7
    s_add_u32 s71, s71, 8192
    v_add_u32 v221, s71, v220
    v_subrev_u32 v219, 0, v60
    v_cmp_gt_u32 vcc, 8, v219
    v_mov_b32 v219, 0x100000
    s_nop 0
    v_cndmask_b32 v221, v219, v221, vcc
    buffer_load_dword v219, v221, s[60:63], 0 offen sc1
K_ngaL:
    s_cmp_lt_u32 s2, 32
    s_cbranch_scc1 K_ngbL
    s_cmp_ge_u32 s2, 96
    s_cbranch_scc1 K_ngbL
    s_mov_b32 s79, 6144
    s_mov_b32 s80, 12288
    s_mov_b32 s81, 18432
    s_mov_b32 s48, s24
    s_mov_b32 s49, s25
    s_mov_b32 s50, 1024
    s_mov_b32 s51, 0x00020000
    s_mov_b32 s52, s26
    s_mov_b32 s53, s27
    s_mov_b32 s54, 3145728
    s_mov_b32 s55, 0x00020000
    buffer_load_dwordx2 v[208:209], v62, s[48:51], 0 offen
    buffer_load_dwordx4 v[192:195], v61, s[52:55], 0 offen
    buffer_load_dwordx4 v[196:199], v61, s[52:55], s79 offen
    buffer_load_dwordx4 v[200:203], v61, s[52:55], s80 offen
    buffer_load_dwordx4 v[204:207], v61, s[52:55], s81 offen
    v_min_u32 v220, 11, v0
    v_lshlrev_b32 v220, 4, v220
    s_lshl_b32 s71, s76, 6
    s_add_u32 s71, s71, 0
    v_add_u32 v221, s71, v220
    v_subrev_u32 v219, 64, v60
    v_cmp_gt_u32 vcc, 4, v219
    v_mov_b32 v219, 0x100000
    s_nop 0
    v_cndmask_b32 v221, v219, v221, vcc
    buffer_load_dword v219, v221, s[60:63], 0 offen sc1
K_ngbL:
    s_cmp_lt_u32 s2, 32
    s_cbranch_scc1 K_xdone
    s_mov_b32 s48, s4
    s_mov_b32 s49, s5
    s_mov_b32 s50, 2097152
    s_mov_b32 s51, 0x00020000
    buffer_load_dwordx4 v[64:67], v21, s[48:51], s77 offen offset:0
    buffer_load_dwordx4 v[68:71], v21, s[48:51], s77 offen offset:1024
    buffer_load_dwordx4 v[72:75], v21, s[48:51], s77 offen offset:2048
    buffer_load_dwordx4 v[76:79], v21, s[48:51], s77 offen offset:3072
    buffer_load_dwordx4 v[80:83], v21, s[48:51], s78 offen offset:0
    buffer_load_dwordx4 v[84:87], v21, s[48:51], s78 offen offset:1024
    buffer_load_dwordx4 v[88:91], v21, s[48:51], s78 offen offset:2048
    buffer_load_dwordx4 v[92:95], v21, s[48:51], s78 offen offset:3072
K_xdone:
    v_lshrrev_b32 v24, 3, v0
    v_and_b32 v25, 7, v0
    v_bfe_u32 v26, v0, 4, 1
    v_lshlrev_b32 v26, 2, v26
    v_xor_b32 v25, v25, v26
    v_lshlrev_b32 v25, 4, v25
    v_mul_u32_u24 v16, 8192, v24
    v_add_u32 v16, v16, v25
    s_lshl_b32 s71, s66, 19
    s_add_u32 s71, s71, 393216
    s_add_u32 s36, s6, s71
    s_addc_u32 s37, s7, 0
    s_mov_b32 s38, 131072
    s_mov_b32 s39, 0x00020000
    s_add_u32 s40, s8, s71
    s_addc_u32 s41, s9, 0
    s_mov_b32 s42, 131072
    s_mov_b32 s43, 0x00020000
    s_mov_b32 s44, s10
    s_mov_b32 s45, s11
    s_mov_b32 s46, 4194304
    s_mov_b32 s47, 0x00020000
    v_lshrrev_b32 v22, 4, v0
    v_and_b32 v23, 15, v0
    v_lshlrev_b32 v24, 2, v22
    v_xor_b32 v24, v24, v23
    v_lshlrev_b32 v24, 4, v24
    v_lshl_add_u32 v15, v22, 8, v24
    v_add_u32 v15, s68, v15
    s_lshl_b32 s71, s64, 1
    s_and_b32 s71, s71, 3
    s_lshl_b32 s71, s71, 4
    v_xor_b32 v13, s71, v15
    s_add_u32 s71, s71, 16
    v_xor_b32 v14, s71, v15
    v_lshrrev_b32 v25, 5, v0
    v_bfe_u32 v26, v0, 2, 2
    v_bfe_u32 v27, v0, 4, 1
    v_lshlrev_b32 v27, 5, v27
    v_and_b32 v28, 1, v0
    v_lshl_add_u32 v27, v28, 4, v27
    v_bfe_u32 v28, v0, 1, 1
    v_lshl_add_u32 v27, v28, 3, v27
    v_lshl_add_u32 v28, v25, 3, v26
    v_lshl_add_u32 v28, v28, 8, v27
    v_add_u32 v28, 0x20000, v28
    v_xor_b32 v29, 0, v26
    v_lshl_add_u32 v1, v29, 6, v28
    v_xor_b32 v29, 1, v26
    v_lshl_add_u32 v2, v29, 6, v28
    v_xor_b32 v29, 2, v26
    v_lshl_add_u32 v3, v29, 6, v28
    v_xor_b32 v29, 3, v26
    v_lshl_add_u32 v4, v29, 6, v28
    v_and_b32 v28, 0x13, v0
    v_and_b32 v29, 4, v0
    v_lshl_add_u32 v28, v29, 1, v28
    v_and_b32 v29, 8, v0
    v_lshrrev_b32 v29, 1, v29
    v_add_u32 v28, v28, v29
    v_and_b32 v29, 3, v28
    v_lshlrev_b32 v29, 2, v29
    v_bfe_u32 v30, v28, 2, 2
    v_or_b32 v29, v29, v30
    v_xor_b32 v29, v29, v25
    v_lshlrev_b32 v29, 4, v29
    v_lshl_add_u32 v5, v28, 8, v29
    v_add_u32 v5, 0x18000, v5
    v_xor_b32 v6, 32, v5
    v_xor_b32 v7, 64, v5
    v_xor_b32 v8, 96, v5
    v_xor_b32 v9, 128, v5
    v_xor_b32 v10, 160, v5
    v_xor_b32 v11, 192, v5
    v_xor_b32 v12, 224, v5
    v_lshrrev_b32 v22, 5, v0
    v_bfe_u32 v23, v0, 2, 2
    v_bfe_u32 v24, v0, 4, 1
    v_lshlrev_b32 v24, 5, v24
    v_and_b32 v25, 1, v0
    v_lshl_add_u32 v24, v25, 4, v24
    v_bfe_u32 v25, v0, 1, 1
    v_lshl_add_u32 v24, v25, 3, v24
    v_lshl_add_u32 v25, v22, 3, v23
    v_lshl_add_u32 v25, v25, 7, v24
    v_add_u32 v25, s69, v25
    v_lshrrev_b32 v26, 1, v23
    v_lshl_add_u32 v32, v26, 6, v25
    v_xor_b32 v33, 64, v32
    v_lshrrev_b32 v22, 5, v0
    v_xor_b32 v23, v22, v0
    v_lshlrev_b32 v23, 4, v23
    v_add_u32 v34, 98304, v23
    v_xor_b32 v35, 32, v34
    v_xor_b32 v36, 64, v34
    v_xor_b32 v37, 96, v34
    v_lshrrev_b32 v22, 1, v0
    v_lshlrev_b32 v38, 11, v22
    v_and_b32 v22, 1, v0
    v_lshl_add_u32 v38, v22, 9, v38
    v_and_b32 v22, 7, v0
    v_lshl_add_u32 v38, v22, 4, v38
    s_lshr_b32 s71, s64, 2
    s_lshl_b32 s71, s71, 10
    s_and_b32 s72, s64, 3
    s_lshl_b32 s72, s72, 7
    s_add_u32 s71, s71, s72
    s_add_u32 s71, s71, 98304
    v_add_u32 v38, s71, v38
    s_cmp_lt_u32 s2, 0
    s_cbranch_scc1 K_ngaC
    s_cmp_ge_u32 s2, 32
    s_cbranch_scc1 K_ngaC
    s_waitcnt vmcnt(5)
    v_lshlrev_b32 v210, 16, v208
    v_and_b32 v211, s67, v208
    v_lshlrev_b32 v212, 16, v209
    v_and_b32 v213, s67, v209
    s_mov_b32 s71, 3216550459
    v_mul_f32 v232, s71, v210
    v_mul_f32 v233, s71, v211
    v_mul_f32 v234, s71, v212
    v_mul_f32 v235, s71, v213
    v_exp_f32 v232, v232
    v_exp_f32 v233, v233
    v_exp_f32 v234, v234
    v_exp_f32 v235, v235
    v_add_f32 v232, 1.0, v232
    v_add_f32 v233, 1.0, v233
    v_add_f32 v234, 1.0, v234
    v_add_f32 v235, 1.0, v235
    v_rcp_f32 v236, v232
    v_rcp_f32 v237, v233
    v_rcp_f32 v238, v234
    v_rcp_f32 v239, v235
    v_mul_f32 v224, v210, v236
    v_mul_f32 v225, v211, v237
    v_mul_f32 v226, v212, v238
    v_mul_f32 v227, v213, v239
    v_fma_f32 v232, -v224, v232, v210
    v_fma_f32 v233, -v225, v233, v211
    v_fma_f32 v234, -v226, v234, v212
    v_fma_f32 v235, -v227, v235, v213
    v_fma_f32 v210, v232, v236, v224
    v_fma_f32 v211, v233, v237, v225
    v_fma_f32 v212, v234, v238, v226
    v_fma_f32 v213, v235, v239, v227
    v_cvt_pk_bf16_f32 v214, v210, v211
    v_lshlrev_b32 v210, 16, v214
    v_and_b32 v211, s67, v214
    v_cvt_pk_bf16_f32 v214, v212, v213
    v_lshlrev_b32 v212, 16, v214
    v_and_b32 v213, s67, v214
    v_lshrrev_b32 v216, 4, v60
    v_lshlrev_b32 v216, 7, v216
    v_and_b32 v217, 3, v60
    v_lshl_add_u32 v216, v217, 5, v216
    v_add_u32 v216, 0, v216
    s_waitcnt vmcnt(4)
    v_lshlrev_b32 v214, 16, v192
    v_and_b32 v215, s67, v192
    v_mul_f32 v224, v210, v214
    v_mul_f32 v225, v210, v215
    v_lshlrev_b32 v214, 16, v193
    v_and_b32 v215, s67, v193
    v_mul_f32 v226, v210, v214
    v_mul_f32 v227, v210, v215
    v_lshlrev_b32 v214, 16, v194
    v_and_b32 v215, s67, v194
    v_mul_f32 v228, v210, v214
    v_mul_f32 v229, v210, v215
    v_lshlrev_b32 v214, 16, v195
    v_and_b32 v215, s67, v195
    v_mul_f32 v230, v210, v214
    v_mul_f32 v231, v210, v215
    s_waitcnt vmcnt(3)
    v_lshlrev_b32 v214, 16, v196
    v_and_b32 v215, s67, v196
    v_fmac_f32 v224, v211, v214
    v_fmac_f32 v225, v211, v215
    v_lshlrev_b32 v214, 16, v197
    v_and_b32 v215, s67, v197
    v_fmac_f32 v226, v211, v214
    v_fmac_f32 v227, v211, v215
    v_lshlrev_b32 v214, 16, v198
    v_and_b32 v215, s67, v198
    v_fmac_f32 v228, v211, v214
    v_fmac_f32 v229, v211, v215
    v_lshlrev_b32 v214, 16, v199
    v_and_b32 v215, s67, v199
    v_fmac_f32 v230, v211, v214
    v_fmac_f32 v231, v211, v215
    s_waitcnt vmcnt(2)
    v_lshlrev_b32 v214, 16, v200
    v_and_b32 v215, s67, v200
    v_fmac_f32 v224, v212, v214
    v_fmac_f32 v225, v212, v215
    v_lshlrev_b32 v214, 16, v201
    v_and_b32 v215, s67, v201
    v_fmac_f32 v226, v212, v214
    v_fmac_f32 v227, v212, v215
    v_lshlrev_b32 v214, 16, v202
    v_and_b32 v215, s67, v202
    v_fmac_f32 v228, v212, v214
    v_fmac_f32 v229, v212, v215
    v_lshlrev_b32 v214, 16, v203
    v_and_b32 v215, s67, v203
    v_fmac_f32 v230, v212, v214
    v_fmac_f32 v231, v212, v215
    s_waitcnt vmcnt(1)
    v_lshlrev_b32 v214, 16, v204
    v_and_b32 v215, s67, v204
    v_fmac_f32 v224, v213, v214
    v_fmac_f32 v225, v213, v215
    v_lshlrev_b32 v214, 16, v205
    v_and_b32 v215, s67, v205
    v_fmac_f32 v226, v213, v214
    v_fmac_f32 v227, v213, v215
    v_lshlrev_b32 v214, 16, v206
    v_and_b32 v215, s67, v206
    v_fmac_f32 v228, v213, v214
    v_fmac_f32 v229, v213, v215
    v_lshlrev_b32 v214, 16, v207
    v_and_b32 v215, s67, v207
    v_fmac_f32 v230, v213, v214
    v_fmac_f32 v231, v213, v215
    s_cmp_eq_u32 s64, 0
    s_cbranch_scc1 K_x1
    s_mov_b32 s48, s4
    s_mov_b32 s49, s5
    s_mov_b32 s50, 2097152
    s_mov_b32 s51, 0x00020000
    buffer_load_dwordx4 v[64:67], v21, s[48:51], s77 offen offset:0
    buffer_load_dwordx4 v[68:71], v21, s[48:51], s77 offen offset:1024
    buffer_load_dwordx4 v[72:75], v21, s[48:51], s77 offen offset:2048
    buffer_load_dwordx4 v[76:79], v21, s[48:51], s77 offen offset:3072
    buffer_load_dwordx4 v[80:83], v21, s[48:51], s78 offen offset:0
    buffer_load_dwordx4 v[84:87], v21, s[48:51], s78 offen offset:1024
    buffer_load_dwordx4 v[88:91], v21, s[48:51], s78 offen offset:2048
    buffer_load_dwordx4 v[92:95], v21, s[48:51], s78 offen offset:3072
K_x1:
    v_add_f32_dpp v224, v224, v224 row_ror:4 row_mask:0xf bank_mask:0xf
    v_add_f32_dpp v225, v225, v225 row_ror:4 row_mask:0xf bank_mask:0xf
    v_add_f32_dpp v226, v226, v226 row_ror:4 row_mask:0xf bank_mask:0xf
    v_add_f32_dpp v227, v227, v227 row_ror:4 row_mask:0xf bank_mask:0xf
    v_add_f32_dpp v228, v228, v228 row_ror:4 row_mask:0xf bank_mask:0xf
    v_add_f32_dpp v229, v229, v229 row_ror:4 row_mask:0xf bank_mask:0xf
    v_add_f32_dpp v230, v230, v230 row_ror:4 row_mask:0xf bank_mask:0xf
    v_add_f32_dpp v231, v231, v231 row_ror:4 row_mask:0xf bank_mask:0xf
    v_add_f32_dpp v224, v224, v224 row_ror:8 row_mask:0xf bank_mask:0xf
    v_add_f32_dpp v225, v225, v225 row_ror:8 row_mask:0xf bank_mask:0xf
    v_add_f32_dpp v226, v226, v226 row_ror:8 row_mask:0xf bank_mask:0xf
    v_add_f32_dpp v227, v227, v227 row_ror:8 row_mask:0xf bank_mask:0xf
    v_add_f32_dpp v228, v228, v228 row_ror:8 row_mask:0xf bank_mask:0xf
    v_add_f32_dpp v229, v229, v229 row_ror:8 row_mask:0xf bank_mask:0xf
    v_add_f32_dpp v230, v230, v230 row_ror:8 row_mask:0xf bank_mask:0xf
    v_add_f32_dpp v231, v231, v231 row_ror:8 row_mask:0xf bank_mask:0xf
    ds_write_b128 v216, v[224:227]
    ds_write_b128 v216, v[228:231] offset:16
    s_waitcnt lgkmcnt(0)
    s_barrier
    s_cmp_lg_u32 s64, 0
    s_cbranch_scc1 K_gbaC
    v_and_b32 v214, 31, v0
    v_lshlrev_b32 v215, 2, v214
    v_lshrrev_b32 v216, 5, v0
    v_lshl_add_u32 v216, v216, 11, v215
    v_add_u32 v216, 0, v216
    ds_read_b32 v232, v216 offset:0
    ds_read_b32 v233, v216 offset:128
    ds_read_b32 v234, v216 offset:256
    ds_read_b32 v235, v216 offset:384
    ds_read_b32 v236, v216 offset:512
    ds_read_b32 v237, v216 offset:640
    ds_read_b32 v238, v216 offset:768
    ds_read_b32 v239, v216 offset:896
    ds_read_b32 v240, v216 offset:1024
    ds_read_b32 v241, v216 offset:1152
    ds_read_b32 v242, v216 offset:1280
    ds_read_b32 v243, v216 offset:1408
    ds_read_b32 v244, v216 offset:1536
    ds_read_b32 v245, v216 offset:1664
    ds_read_b32 v246, v216 offset:1792
    ds_read_b32 v247, v216 offset:1920
    s_waitcnt lgkmcnt(0)
    v_pk_add_f32 v[232:233], v[232:233], v[240:241]
    v_pk_add_f32 v[234:235], v[234:235], v[242:243]
    v_pk_add_f32 v[236:237], v[236:237], v[244:245]
    v_pk_add_f32 v[238:239], v[238:239], v[246:247]
    v_pk_add_f32 v[232:233], v[232:233], v[236:237]
    v_pk_add_f32 v[234:235], v[234:235], v[238:239]
    v_pk_add_f32 v[232:233], v[232:233], v[234:235]
    v_add_f32 v232, v232, v233
    v_mov_b32 v233, v232
    s_nop 1
    v_permlane32_swap_b32 v232, v233
    v_add_f32 v232, v232, v233
    v_cvt_pk_bf16_f32 v232, v232, v232
    v_and_b32 v233, s67, v232
    v_add_f32 v234, 1.0, v233
    v_cvt_pk_bf16_f32 v234, v234, v234
    v_and_b32 v234, s67, v234
    s_cmp_ge_u32 s76, 16
    s_cselect_b64 vcc, -1, 0
    v_cndmask_b32 v233, v233, v234, vcc
    v_mul_f32 v233, 1040356334, v233
    v_add_u32 v215, 4096, v215
    ds_write_b32 v215, v233
    v_add_u32 v217, 4096, v220
    v_mov_b32 v235, 1
    s_waitcnt lgkmcnt(0)
    ds_read_b128 v[236:239], v217
    s_waitcnt lgkmcnt(0)
    buffer_store_dwordx4 v[236:239], v221, s[60:63], 0 offen sc1
    s_waitcnt vmcnt(0)
    buffer_atomic_add v235, v39, s[56:59], 0 offen sc0 sc1
    v_add_u32 v236, 1, v63
    s_waitcnt vmcnt(0)
    v_readfirstlane_b32 s71, v235
    s_nop 0
    s_cmp_lg_u32 s71, 31
    s_cbranch_scc1 K_gbaC
    buffer_store_dword v236, v59, s[60:63], 0 offen sc1
K_gbaC:
K_ngaC:
    s_waitcnt vmcnt(7)
    v_lshlrev_b32 v128, 16, v64
    v_and_b32 v129, s67, v64
    v_lshlrev_b32 v130, 16, v65
    v_and_b32 v131, s67, v65
    v_lshlrev_b32 v132, 16, v66
    v_and_b32 v133, s67, v66
    v_lshlrev_b32 v134, 16, v67
    v_and_b32 v135, s67, v67
    v_pk_add_f32 v[120:121], v[128:129], v[130:131]
    v_pk_mul_f32 v[122:123], v[128:129], v[128:129]
    v_pk_add_f32 v[120:121], v[120:121], v[132:133]
    v_pk_fma_f32 v[122:123], v[130:131], v[130:131], v[122:123]
    v_pk_add_f32 v[120:121], v[120:121], v[134:135]
    v_pk_fma_f32 v[122:123], v[132:133], v[132:133], v[122:123]
    v_add_f32 v40, v120, v121
    v_pk_fma_f32 v[122:123], v[134:135], v[134:135], v[122:123]
    v_add_f32 v48, v122, v123
    s_waitcnt vmcnt(6)
    v_lshlrev_b32 v136, 16, v68
    v_and_b32 v137, s67, v68
    v_lshlrev_b32 v138, 16, v69
    v_and_b32 v139, s67, v69
    v_lshlrev_b32 v140, 16, v70
    v_and_b32 v141, s67, v70
    v_lshlrev_b32 v142, 16, v71
    v_and_b32 v143, s67, v71
    v_pk_add_f32 v[120:121], v[136:137], v[138:139]
    v_pk_mul_f32 v[122:123], v[136:137], v[136:137]
    v_pk_add_f32 v[120:121], v[120:121], v[140:141]
    v_pk_fma_f32 v[122:123], v[138:139], v[138:139], v[122:123]
    v_pk_add_f32 v[120:121], v[120:121], v[142:143]
    v_pk_fma_f32 v[122:123], v[140:141], v[140:141], v[122:123]
    v_add_f32 v41, v120, v121
    v_pk_fma_f32 v[122:123], v[142:143], v[142:143], v[122:123]
    v_add_f32 v49, v122, v123
    s_waitcnt vmcnt(5)
    v_lshlrev_b32 v144, 16, v72
    v_and_b32 v145, s67, v72
    v_lshlrev_b32 v146, 16, v73
    v_and_b32 v147, s67, v73
    v_lshlrev_b32 v148, 16, v74
    v_and_b32 v149, s67, v74
    v_lshlrev_b32 v150, 16, v75
    v_and_b32 v151, s67, v75
    v_pk_add_f32 v[120:121], v[144:145], v[146:147]
    v_pk_mul_f32 v[122:123], v[144:145], v[144:145]
    v_pk_add_f32 v[120:121], v[120:121], v[148:149]
    v_pk_fma_f32 v[122:123], v[146:147], v[146:147], v[122:123]
    v_pk_add_f32 v[120:121], v[120:121], v[150:151]
    v_pk_fma_f32 v[122:123], v[148:149], v[148:149], v[122:123]
    v_add_f32 v42, v120, v121
    v_pk_fma_f32 v[122:123], v[150:151], v[150:151], v[122:123]
    v_add_f32 v50, v122, v123
    s_waitcnt vmcnt(4)
    v_lshlrev_b32 v152, 16, v76
    v_and_b32 v153, s67, v76
    v_lshlrev_b32 v154, 16, v77
    v_and_b32 v155, s67, v77
    v_lshlrev_b32 v156, 16, v78
    v_and_b32 v157, s67, v78
    v_lshlrev_b32 v158, 16, v79
    v_and_b32 v159, s67, v79
    v_pk_add_f32 v[120:121], v[152:153], v[154:155]
    v_pk_mul_f32 v[122:123], v[152:153], v[152:153]
    v_pk_add_f32 v[120:121], v[120:121], v[156:157]
    v_pk_fma_f32 v[122:123], v[154:155], v[154:155], v[122:123]
    v_pk_add_f32 v[120:121], v[120:121], v[158:159]
    v_pk_fma_f32 v[122:123], v[156:157], v[156:157], v[122:123]
    v_add_f32 v43, v120, v121
    v_pk_fma_f32 v[122:123], v[158:159], v[158:159], v[122:123]
    v_add_f32 v51, v122, v123
    s_waitcnt vmcnt(3)
    v_lshlrev_b32 v160, 16, v80
    v_and_b32 v161, s67, v80
    v_lshlrev_b32 v162, 16, v81
    v_and_b32 v163, s67, v81
    v_lshlrev_b32 v164, 16, v82
    v_and_b32 v165, s67, v82
    v_lshlrev_b32 v166, 16, v83
    v_and_b32 v167, s67, v83
    v_pk_add_f32 v[120:121], v[160:161], v[162:163]
    v_pk_mul_f32 v[122:123], v[160:161], v[160:161]
    v_pk_add_f32 v[120:121], v[120:121], v[164:165]
    v_pk_fma_f32 v[122:123], v[162:163], v[162:163], v[122:123]
    v_pk_add_f32 v[120:121], v[120:121], v[166:167]
    v_pk_fma_f32 v[122:123], v[164:165], v[164:165], v[122:123]
    v_add_f32 v44, v120, v121
    v_pk_fma_f32 v[122:123], v[166:167], v[166:167], v[122:123]
    v_add_f32 v52, v122, v123
    s_waitcnt vmcnt(2)
    v_lshlrev_b32 v168, 16, v84
    v_and_b32 v169, s67, v84
    v_lshlrev_b32 v170, 16, v85
    v_and_b32 v171, s67, v85
    v_lshlrev_b32 v172, 16, v86
    v_and_b32 v173, s67, v86
    v_lshlrev_b32 v174, 16, v87
    v_and_b32 v175, s67, v87
    v_pk_add_f32 v[120:121], v[168:169], v[170:171]
    v_pk_mul_f32 v[122:123], v[168:169], v[168:169]
    v_pk_add_f32 v[120:121], v[120:121], v[172:173]
    v_pk_fma_f32 v[122:123], v[170:171], v[170:171], v[122:123]
    v_pk_add_f32 v[120:121], v[120:121], v[174:175]
    v_pk_fma_f32 v[122:123], v[172:173], v[172:173], v[122:123]
    v_add_f32 v45, v120, v121
    v_pk_fma_f32 v[122:123], v[174:175], v[174:175], v[122:123]
    v_add_f32 v53, v122, v123
    s_waitcnt vmcnt(1)
    v_lshlrev_b32 v176, 16, v88
    v_and_b32 v177, s67, v88
    v_lshlrev_b32 v178, 16, v89
    v_and_b32 v179, s67, v89
    v_lshlrev_b32 v180, 16, v90
    v_and_b32 v181, s67, v90
    v_lshlrev_b32 v182, 16, v91
    v_and_b32 v183, s67, v91
    v_pk_add_f32 v[120:121], v[176:177], v[178:179]
    v_pk_mul_f32 v[122:123], v[176:177], v[176:177]
    v_pk_add_f32 v[120:121], v[120:121], v[180:181]
    v_pk_fma_f32 v[122:123], v[178:179], v[178:179], v[122:123]
    v_pk_add_f32 v[120:121], v[120:121], v[182:183]
    v_pk_fma_f32 v[122:123], v[180:181], v[180:181], v[122:123]
    v_add_f32 v46, v120, v121
    v_pk_fma_f32 v[122:123], v[182:183], v[182:183], v[122:123]
    v_add_f32 v54, v122, v123
    s_waitcnt vmcnt(0)
    v_lshlrev_b32 v184, 16, v92
    v_and_b32 v185, s67, v92
    v_lshlrev_b32 v186, 16, v93
    v_and_b32 v187, s67, v93
    v_lshlrev_b32 v188, 16, v94
    v_and_b32 v189, s67, v94
    v_lshlrev_b32 v190, 16, v95
    v_and_b32 v191, s67, v95
    v_pk_add_f32 v[120:121], v[184:185], v[186:187]
    v_pk_mul_f32 v[122:123], v[184:185], v[184:185]
    v_pk_add_f32 v[120:121], v[120:121], v[188:189]
    v_pk_fma_f32 v[122:123], v[186:187], v[186:187], v[122:123]
    v_pk_add_f32 v[120:121], v[120:121], v[190:191]
    v_pk_fma_f32 v[122:123], v[188:189], v[188:189], v[122:123]
    v_add_f32 v47, v120, v121
    v_pk_fma_f32 v[122:123], v[190:191], v[190:191], v[122:123]
    v_add_f32 v55, v122, v123
    s_add_u32 m0, s69, 0
    s_add_u32 s72, s70, 65536
    buffer_load_dwordx4 v16, s[44:47], s70 offen lds
    s_add_u32 m0, s69, 1024
    s_add_u32 s70, s70, 131072
    buffer_load_dwordx4 v16, s[44:47], s72 offen lds
    s_add_u32 m0, s69, 2048
    s_add_u32 s72, s70, 65536
    buffer_load_dwordx4 v16, s[44:47], s70 offen lds
    s_add_u32 m0, s69, 3072
    s_add_u32 s70, s70, 131072
    buffer_load_dwordx4 v16, s[44:47], s72 offen lds
    s_add_u32 m0, s69, 4096
    s_add_u32 s72, s70, 65536
    buffer_load_dwordx4 v16, s[44:47], s70 offen lds
    s_add_u32 m0, s69, 5120
    s_add_u32 s70, s70, 131072
    buffer_load_dwordx4 v16, s[44:47], s72 offen lds
    s_add_u32 m0, s69, 6144
    s_add_u32 s72, s70, 65536
    buffer_load_dwordx4 v16, s[44:47], s70 offen lds
    s_add_u32 m0, s69, 7168
    s_add_u32 s70, s70, 131072
    buffer_load_dwordx4 v16, s[44:47], s72 offen lds
    s_add_u32 m0, s69, 8192
    s_add_u32 s72, s70, 65536
    buffer_load_dwordx4 v16, s[44:47], s70 offen lds
    s_add_u32 m0, s69, 9216
    s_add_u32 s70, s70, 131072
    buffer_load_dwordx4 v16, s[44:47], s72 offen lds
    s_add_u32 m0, s69, 10240
    s_add_u32 s72, s70, 65536
    buffer_load_dwordx4 v16, s[44:47], s70 offen lds
    s_add_u32 m0, s69, 11264
    s_add_u32 s70, s70, 131072
    buffer_load_dwordx4 v16, s[44:47], s72 offen lds
    v_add_f32_dpp v40, v40, v40 quad_perm:[1,0,3,2] row_mask:0xf bank_mask:0xf
    v_add_f32_dpp v41, v41, v41 quad_perm:[1,0,3,2] row_mask:0xf bank_mask:0xf
    v_add_f32_dpp v42, v42, v42 quad_perm:[1,0,3,2] row_mask:0xf bank_mask:0xf
    v_add_f32_dpp v43, v43, v43 quad_perm:[1,0,3,2] row_mask:0xf bank_mask:0xf
    v_add_f32_dpp v44, v44, v44 quad_perm:[1,0,3,2] row_mask:0xf bank_mask:0xf
    v_add_f32_dpp v45, v45, v45 quad_perm:[1,0,3,2] row_mask:0xf bank_mask:0xf
    v_add_f32_dpp v46, v46, v46 quad_perm:[1,0,3,2] row_mask:0xf bank_mask:0xf
    v_add_f32_dpp v47, v47, v47 quad_perm:[1,0,3,2] row_mask:0xf bank_mask:0xf
    v_add_f32_dpp v48, v48, v48 quad_perm:[1,0,3,2] row_mask:0xf bank_mask:0xf
    v_add_f32_dpp v49, v49, v49 quad_perm:[1,0,3,2] row_mask:0xf bank_mask:0xf
    v_add_f32_dpp v50, v50, v50 quad_perm:[1,0,3,2] row_mask:0xf bank_mask:0xf
    v_add_f32_dpp v51, v51, v51 quad_perm:[1,0,3,2] row_mask:0xf bank_mask:0xf
    v_add_f32_dpp v52, v52, v52 quad_perm:[1,0,3,2] row_mask:0xf bank_mask:0xf
    v_add_f32_dpp v53, v53, v53 quad_perm:[1,0,3,2] row_mask:0xf bank_mask:0xf
    v_add_f32_dpp v54, v54, v54 quad_perm:[1,0,3,2] row_mask:0xf bank_mask:0xf
    v_add_f32_dpp v55, v55, v55 quad_perm:[1,0,3,2] row_mask:0xf bank_mask:0xf
    v_add_f32_dpp v40, v40, v40 quad_perm:[2,3,0,1] row_mask:0xf bank_mask:0xf
    v_add_f32_dpp v41, v41, v41 quad_perm:[2,3,0,1] row_mask:0xf bank_mask:0xf
    v_add_f32_dpp v42, v42, v42 quad_perm:[2,3,0,1] row_mask:0xf bank_mask:0xf
    v_add_f32_dpp v43, v43, v43 quad_perm:[2,3,0,1] row_mask:0xf bank_mask:0xf
    v_add_f32_dpp v44, v44, v44 quad_perm:[2,3,0,1] row_mask:0xf bank_mask:0xf
    v_add_f32_dpp v45, v45, v45 quad_perm:[2,3,0,1] row_mask:0xf bank_mask:0xf
    v_add_f32_dpp v46, v46, v46 quad_perm:[2,3,0,1] row_mask:0xf bank_mask:0xf
    v_add_f32_dpp v47, v47, v47 quad_perm:[2,3,0,1] row_mask:0xf bank_mask:0xf
    v_add_f32_dpp v48, v48, v48 quad_perm:[2,3,0,1] row_mask:0xf bank_mask:0xf
    v_add_f32_dpp v49, v49, v49 quad_perm:[2,3,0,1] row_mask:0xf bank_mask:0xf
    v_add_f32_dpp v50, v50, v50 quad_perm:[2,3,0,1] row_mask:0xf bank_mask:0xf
    v_add_f32_dpp v51, v51, v51 quad_perm:[2,3,0,1] row_mask:0xf bank_mask:0xf
    v_add_f32_dpp v52, v52, v52 quad_perm:[2,3,0,1] row_mask:0xf bank_mask:0xf
    v_add_f32_dpp v53, v53, v53 quad_perm:[2,3,0,1] row_mask:0xf bank_mask:0xf
    v_add_f32_dpp v54, v54, v54 quad_perm:[2,3,0,1] row_mask:0xf bank_mask:0xf
    v_add_f32_dpp v55, v55, v55 quad_perm:[2,3,0,1] row_mask:0xf bank_mask:0xf
    v_add_f32_dpp v40, v40, v40 row_half_mirror row_mask:0xf bank_mask:0xf
    v_add_f32_dpp v41, v41, v41 row_half_mirror row_mask:0xf bank_mask:0xf
    v_add_f32_dpp v42, v42, v42 row_half_mirror row_mask:0xf bank_mask:0xf
    v_add_f32_dpp v43, v43, v43 row_half_mirror row_mask:0xf bank_mask:0xf
    v_add_f32_dpp v44, v44, v44 row_half_mirror row_mask:0xf bank_mask:0xf
    v_add_f32_dpp v45, v45, v45 row_half_mirror row_mask:0xf bank_mask:0xf
    v_add_f32_dpp v46, v46, v46 row_half_mirror row_mask:0xf bank_mask:0xf
    v_add_f32_dpp v47, v47, v47 row_half_mirror row_mask:0xf bank_mask:0xf
    v_add_f32_dpp v48, v48, v48 row_half_mirror row_mask:0xf bank_mask:0xf
    v_add_f32_dpp v49, v49, v49 row_half_mirror row_mask:0xf bank_mask:0xf
    v_add_f32_dpp v50, v50, v50 row_half_mirror row_mask:0xf bank_mask:0xf
    v_add_f32_dpp v51, v51, v51 row_half_mirror row_mask:0xf bank_mask:0xf
    v_add_f32_dpp v52, v52, v52 row_half_mirror row_mask:0xf bank_mask:0xf
    v_add_f32_dpp v53, v53, v53 row_half_mirror row_mask:0xf bank_mask:0xf
    v_add_f32_dpp v54, v54, v54 row_half_mirror row_mask:0xf bank_mask:0xf
    v_add_f32_dpp v55, v55, v55 row_half_mirror row_mask:0xf bank_mask:0xf
    v_add_f32_dpp v40, v40, v40 row_mirror row_mask:0xf bank_mask:0xf
    v_add_f32_dpp v41, v41, v41 row_mirror row_mask:0xf bank_mask:0xf
    v_add_f32_dpp v42, v42, v42 row_mirror row_mask:0xf bank_mask:0xf
    v_add_f32_dpp v43, v43, v43 row_mirror row_mask:0xf bank_mask:0xf
    v_add_f32_dpp v44, v44, v44 row_mirror row_mask:0xf bank_mask:0xf
    v_add_f32_dpp v45, v45, v45 row_mirror row_mask:0xf bank_mask:0xf
    v_add_f32_dpp v46, v46, v46 row_mirror row_mask:0xf bank_mask:0xf
    v_add_f32_dpp v47, v47, v47 row_mirror row_mask:0xf bank_mask:0xf
    v_add_f32_dpp v48, v48, v48 row_mirror row_mask:0xf bank_mask:0xf
    v_add_f32_dpp v49, v49, v49 row_mirror row_mask:0xf bank_mask:0xf
    v_add_f32_dpp v50, v50, v50 row_mirror row_mask:0xf bank_mask:0xf
    v_add_f32_dpp v51, v51, v51 row_mirror row_mask:0xf bank_mask:0xf
    v_add_f32_dpp v52, v52, v52 row_mirror row_mask:0xf bank_mask:0xf
    v_add_f32_dpp v53, v53, v53 row_mirror row_mask:0xf bank_mask:0xf
    v_add_f32_dpp v54, v54, v54 row_mirror row_mask:0xf bank_mask:0xf
    v_add_f32_dpp v55, v55, v55 row_mirror row_mask:0xf bank_mask:0xf
    v_pk_mov_b32 v[64:65], v[40:41], v[40:41] op_sel:[0,1]
    v_pk_mov_b32 v[66:67], v[42:43], v[42:43] op_sel:[0,1]
    v_pk_mov_b32 v[68:69], v[44:45], v[44:45] op_sel:[0,1]
    v_pk_mov_b32 v[70:71], v[46:47], v[46:47] op_sel:[0,1]
    v_pk_mov_b32 v[72:73], v[48:49], v[48:49] op_sel:[0,1]
    v_pk_mov_b32 v[74:75], v[50:51], v[50:51] op_sel:[0,1]
    v_pk_mov_b32 v[76:77], v[52:53], v[52:53] op_sel:[0,1]
    v_pk_mov_b32 v[78:79], v[54:55], v[54:55] op_sel:[0,1]
    v_permlane16_swap_b32 v40, v64
    v_permlane16_swap_b32 v41, v65
    v_permlane16_swap_b32 v42, v66
    v_permlane16_swap_b32 v43, v67
    v_permlane16_swap_b32 v44, v68
    v_permlane16_swap_b32 v45, v69
    v_permlane16_swap_b32 v46, v70
    v_permlane16_swap_b32 v47, v71
    v_permlane16_swap_b32 v48, v72
    v_permlane16_swap_b32 v49, v73
    v_permlane16_swap_b32 v50, v74
    v_permlane16_swap_b32 v51, v75
    v_permlane16_swap_b32 v52, v76
    v_permlane16_swap_b32 v53, v77
    v_permlane16_swap_b32 v54, v78
    v_permlane16_swap_b32 v55, v79
    v_pk_add_f32 v[40:41], v[40:41], v[64:65]
    v_pk_add_f32 v[42:43], v[42:43], v[66:67]
    v_pk_add_f32 v[44:45], v[44:45], v[68:69]
    v_pk_add_f32 v[46:47], v[46:47], v[70:71]
    v_pk_add_f32 v[48:49], v[48:49], v[72:73]
    v_pk_add_f32 v[50:51], v[50:51], v[74:75]
    v_pk_add_f32 v[52:53], v[52:53], v[76:77]
    v_pk_add_f32 v[54:55], v[54:55], v[78:79]
    v_pk_mov_b32 v[64:65], v[40:41], v[40:41] op_sel:[0,1]
    v_pk_mov_b32 v[66:67], v[42:43], v[42:43] op_sel:[0,1]
    v_pk_mov_b32 v[68:69], v[44:45], v[44:45] op_sel:[0,1]
    v_pk_mov_b32 v[70:71], v[46:47], v[46:47] op_sel:[0,1]
    v_pk_mov_b32 v[72:73], v[48:49], v[48:49] op_sel:[0,1]
    v_pk_mov_b32 v[74:75], v[50:51], v[50:51] op_sel:[0,1]
    v_pk_mov_b32 v[76:77], v[52:53], v[52:53] op_sel:[0,1]
    v_pk_mov_b32 v[78:79], v[54:55], v[54:55] op_sel:[0,1]
    v_permlane32_swap_b32 v40, v64
    v_permlane32_swap_b32 v41, v65
    v_permlane32_swap_b32 v42, v66
    v_permlane32_swap_b32 v43, v67
    v_permlane32_swap_b32 v44, v68
    v_permlane32_swap_b32 v45, v69
    v_permlane32_swap_b32 v46, v70
    v_permlane32_swap_b32 v47, v71
    v_permlane32_swap_b32 v48, v72
    v_permlane32_swap_b32 v49, v73
    v_permlane32_swap_b32 v50, v74
    v_permlane32_swap_b32 v51, v75
    v_permlane32_swap_b32 v52, v76
    v_permlane32_swap_b32 v53, v77
    v_permlane32_swap_b32 v54, v78
    v_permlane32_swap_b32 v55, v79
    v_pk_add_f32 v[40:41], v[40:41], v[64:65]
    v_pk_add_f32 v[42:43], v[42:43], v[66:67]
    v_pk_add_f32 v[44:45], v[44:45], v[68:69]
    v_pk_add_f32 v[46:47], v[46:47], v[70:71]
    v_pk_add_f32 v[48:49], v[48:49], v[72:73]
    v_pk_add_f32 v[50:51], v[50:51], v[74:75]
    v_pk_add_f32 v[52:53], v[52:53], v[76:77]
    v_pk_add_f32 v[54:55], v[54:55], v[78:79]
    s_mov_b32 s71, 989855744
    v_mul_f32 v40, s71, v40
    v_mul_f32 v41, s71, v41
    v_mul_f32 v42, s71, v42
    v_mul_f32 v43, s71, v43
    v_mul_f32 v44, s71, v44
    v_mul_f32 v45, s71, v45
    v_mul_f32 v46, s71, v46
    v_mul_f32 v47, s71, v47
    v_mul_f32 v48, s71, v48
    v_mul_f32 v49, s71, v49
    v_mul_f32 v50, s71, v50
    v_mul_f32 v51, s71, v51
    v_mul_f32 v52, s71, v52
    v_mul_f32 v53, s71, v53
    v_mul_f32 v54, s71, v54
    v_mul_f32 v55, s71, v55
    v_fma_f32 v48, -v40, v40, v48
    v_fma_f32 v49, -v41, v41, v49
    v_fma_f32 v50, -v42, v42, v50
    v_fma_f32 v51, -v43, v43, v51
    v_fma_f32 v52, -v44, v44, v52
    v_fma_f32 v53, -v45, v45, v53
    v_fma_f32 v54, -v46, v46, v54
    v_fma_f32 v55, -v47, v47, v55
    v_max_f32 v48, 0, v48
    v_max_f32 v49, 0, v49
    v_max_f32 v50, 0, v50
    v_max_f32 v51, 0, v51
    v_max_f32 v52, 0, v52
    v_max_f32 v53, 0, v53
    v_max_f32 v54, 0, v54
    v_max_f32 v55, 0, v55
    v_cvt_pk_bf16_f32 v64, v40, v41
    v_lshlrev_b32 v40, 16, v64
    v_and_b32 v41, s67, v64
    v_cvt_pk_bf16_f32 v65, v42, v43
    v_lshlrev_b32 v42, 16, v65
    v_and_b32 v43, s67, v65
    v_cvt_pk_bf16_f32 v66, v44, v45
    v_lshlrev_b32 v44, 16, v66
    v_and_b32 v45, s67, v66
    v_cvt_pk_bf16_f32 v67, v46, v47
    v_lshlrev_b32 v46, 16, v67
    v_and_b32 v47, s67, v67
    v_cvt_pk_bf16_f32 v68, v48, v49
    v_lshlrev_b32 v48, 16, v68
    v_and_b32 v49, s67, v68
    v_cvt_pk_bf16_f32 v69, v50, v51
    v_lshlrev_b32 v50, 16, v69
    v_and_b32 v51, s67, v69
    v_cvt_pk_bf16_f32 v70, v52, v53
    v_lshlrev_b32 v52, 16, v70
    v_and_b32 v53, s67, v70
    v_cvt_pk_bf16_f32 v71, v54, v55
    v_lshlrev_b32 v54, 16, v71
    v_and_b32 v55, s67, v71
    v_add_f32 v48, 925353388, v48
    v_add_f32 v49, 925353388, v49
    v_add_f32 v50, 925353388, v50
    v_add_f32 v51, 925353388, v51
    v_add_f32 v52, 925353388, v52
    v_add_f32 v53, 925353388, v53
    v_add_f32 v54, 925353388, v54
    v_add_f32 v55, 925353388, v55
    v_cvt_pk_bf16_f32 v64, v48, v49
    v_lshlrev_b32 v48, 16, v64
    v_and_b32 v49, s67, v64
    v_cvt_pk_bf16_f32 v65, v50, v51
    v_lshlrev_b32 v50, 16, v65
    v_and_b32 v51, s67, v65
    v_cvt_pk_bf16_f32 v66, v52, v53
    v_lshlrev_b32 v52, 16, v66
    v_and_b32 v53, s67, v66
    v_cvt_pk_bf16_f32 v67, v54, v55
    v_lshlrev_b32 v54, 16, v67
    v_and_b32 v55, s67, v67
    v_sqrt_f32 v48, v48
    v_sqrt_f32 v49, v49
    v_sqrt_f32 v50, v50
    v_sqrt_f32 v51, v51
    v_sqrt_f32 v52, v52
    v_sqrt_f32 v53, v53
    v_sqrt_f32 v54, v54
    v_sqrt_f32 v55, v55
    v_cvt_pk_bf16_f32 v64, v48, v49
    v_lshlrev_b32 v48, 16, v64
    v_and_b32 v49, s67, v64
    v_cvt_pk_bf16_f32 v65, v50, v51
    v_lshlrev_b32 v50, 16, v65
    v_and_b32 v51, s67, v65
    v_cvt_pk_bf16_f32 v66, v52, v53
    v_lshlrev_b32 v52, 16, v66
    v_and_b32 v53, s67, v66
    v_cvt_pk_bf16_f32 v67, v54, v55
    v_lshlrev_b32 v54, 16, v67
    v_and_b32 v55, s67, v67
    v_rcp_f32 v64, v48
    v_rcp_f32 v66, v49
    v_rcp_f32 v68, v50
    v_rcp_f32 v70, v51
    v_rcp_f32 v72, v52
    v_rcp_f32 v74, v53
    v_rcp_f32 v76, v54
    v_rcp_f32 v78, v55
    v_mul_f32 v65, -v40, v64
    v_mul_f32 v67, -v41, v66
    v_mul_f32 v69, -v42, v68
    v_mul_f32 v71, -v43, v70
    v_mul_f32 v73, -v44, v72
    v_mul_f32 v75, -v45, v74
    v_mul_f32 v77, -v46, v76
    v_mul_f32 v79, -v47, v78
    v_pk_fma_f32 v[128:129], v[128:129], v[64:65], v[64:65] op_sel:[0,0,1] op_sel_hi:[1,0,1]
    v_pk_fma_f32 v[130:131], v[130:131], v[64:65], v[64:65] op_sel:[0,0,1] op_sel_hi:[1,0,1]
    v_pk_fma_f32 v[132:133], v[132:133], v[64:65], v[64:65] op_sel:[0,0,1] op_sel_hi:[1,0,1]
    v_pk_fma_f32 v[134:135], v[134:135], v[64:65], v[64:65] op_sel:[0,0,1] op_sel_hi:[1,0,1]
    v_pk_fma_f32 v[136:137], v[136:137], v[66:67], v[66:67] op_sel:[0,0,1] op_sel_hi:[1,0,1]
    v_pk_fma_f32 v[138:139], v[138:139], v[66:67], v[66:67] op_sel:[0,0,1] op_sel_hi:[1,0,1]
    v_pk_fma_f32 v[140:141], v[140:141], v[66:67], v[66:67] op_sel:[0,0,1] op_sel_hi:[1,0,1]
    v_pk_fma_f32 v[142:143], v[142:143], v[66:67], v[66:67] op_sel:[0,0,1] op_sel_hi:[1,0,1]
    v_pk_fma_f32 v[144:145], v[144:145], v[68:69], v[68:69] op_sel:[0,0,1] op_sel_hi:[1,0,1]
    v_pk_fma_f32 v[146:147], v[146:147], v[68:69], v[68:69] op_sel:[0,0,1] op_sel_hi:[1,0,1]
    v_pk_fma_f32 v[148:149], v[148:149], v[68:69], v[68:69] op_sel:[0,0,1] op_sel_hi:[1,0,1]
    v_pk_fma_f32 v[150:151], v[150:151], v[68:69], v[68:69] op_sel:[0,0,1] op_sel_hi:[1,0,1]
    v_pk_fma_f32 v[152:153], v[152:153], v[70:71], v[70:71] op_sel:[0,0,1] op_sel_hi:[1,0,1]
    v_pk_fma_f32 v[154:155], v[154:155], v[70:71], v[70:71] op_sel:[0,0,1] op_sel_hi:[1,0,1]
    v_pk_fma_f32 v[156:157], v[156:157], v[70:71], v[70:71] op_sel:[0,0,1] op_sel_hi:[1,0,1]
    v_pk_fma_f32 v[158:159], v[158:159], v[70:71], v[70:71] op_sel:[0,0,1] op_sel_hi:[1,0,1]
    v_pk_fma_f32 v[160:161], v[160:161], v[72:73], v[72:73] op_sel:[0,0,1] op_sel_hi:[1,0,1]
    v_pk_fma_f32 v[162:163], v[162:163], v[72:73], v[72:73] op_sel:[0,0,1] op_sel_hi:[1,0,1]
    v_pk_fma_f32 v[164:165], v[164:165], v[72:73], v[72:73] op_sel:[0,0,1] op_sel_hi:[1,0,1]
    v_pk_fma_f32 v[166:167], v[166:167], v[72:73], v[72:73] op_sel:[0,0,1] op_sel_hi:[1,0,1]
    v_pk_fma_f32 v[168:169], v[168:169], v[74:75], v[74:75] op_sel:[0,0,1] op_sel_hi:[1,0,1]
    v_pk_fma_f32 v[170:171], v[170:171], v[74:75], v[74:75] op_sel:[0,0,1] op_sel_hi:[1,0,1]
    v_pk_fma_f32 v[172:173], v[172:173], v[74:75], v[74:75] op_sel:[0,0,1] op_sel_hi:[1,0,1]
    v_pk_fma_f32 v[174:175], v[174:175], v[74:75], v[74:75] op_sel:[0,0,1] op_sel_hi:[1,0,1]
    v_pk_fma_f32 v[176:177], v[176:177], v[76:77], v[76:77] op_sel:[0,0,1] op_sel_hi:[1,0,1]
    v_pk_fma_f32 v[178:179], v[178:179], v[76:77], v[76:77] op_sel:[0,0,1] op_sel_hi:[1,0,1]
    v_pk_fma_f32 v[180:181], v[180:181], v[76:77], v[76:77] op_sel:[0,0,1] op_sel_hi:[1,0,1]
    v_pk_fma_f32 v[182:183], v[182:183], v[76:77], v[76:77] op_sel:[0,0,1] op_sel_hi:[1,0,1]
    v_pk_fma_f32 v[184:185], v[184:185], v[78:79], v[78:79] op_sel:[0,0,1] op_sel_hi:[1,0,1]
    v_pk_fma_f32 v[186:187], v[186:187], v[78:79], v[78:79] op_sel:[0,0,1] op_sel_hi:[1,0,1]
    v_pk_fma_f32 v[188:189], v[188:189], v[78:79], v[78:79] op_sel:[0,0,1] op_sel_hi:[1,0,1]
    v_pk_fma_f32 v[190:191], v[190:191], v[78:79], v[78:79] op_sel:[0,0,1] op_sel_hi:[1,0,1]
    s_lshl_b32 s71, s2, 14
    s_sub_u32 s72, s64, 1
    s_mul_i32 s72, s72, 2432
    s_add_u32 s71, s71, s72
    s_cmp_eq_u32 s64, 0
    s_cselect_b32 s71, 0x1000000, s71
    v_min_u32 v22, 18, v0
    v_lshlrev_b32 v22, 7, v22
    buffer_load_dword v31, v22, s[44:47], s71 offen
    s_cmp_lt_u32 s2, 32
    s_cbranch_scc1 K_ngbC
    s_cmp_ge_u32 s2, 96
    s_cbranch_scc1 K_ngbC
    v_lshlrev_b32 v210, 16, v208
    v_and_b32 v211, s67, v208
    v_lshlrev_b32 v212, 16, v209
    v_and_b32 v213, s67, v209
    s_mov_b32 s71, 3216550459
    v_mul_f32 v232, s71, v210
    v_mul_f32 v233, s71, v211
    v_mul_f32 v234, s71, v212
    v_mul_f32 v235, s71, v213
    v_exp_f32 v232, v232
    v_exp_f32 v233, v233
    v_exp_f32 v234, v234
    v_exp_f32 v235, v235
    v_add_f32 v232, 1.0, v232
    v_add_f32 v233, 1.0, v233
    v_add_f32 v234, 1.0, v234
    v_add_f32 v235, 1.0, v235
    v_rcp_f32 v236, v232
    v_rcp_f32 v237, v233
    v_rcp_f32 v238, v234
    v_rcp_f32 v239, v235
    v_mul_f32 v224, v210, v236
    v_mul_f32 v225, v211, v237
    v_mul_f32 v226, v212, v238
    v_mul_f32 v227, v213, v239
    v_fma_f32 v232, -v224, v232, v210
    v_fma_f32 v233, -v225, v233, v211
    v_fma_f32 v234, -v226, v234, v212
    v_fma_f32 v235, -v227, v235, v213
    v_fma_f32 v210, v232, v236, v224
    v_fma_f32 v211, v233, v237, v225
    v_fma_f32 v212, v234, v238, v226
    v_fma_f32 v213, v235, v239, v227
    v_cvt_pk_bf16_f32 v214, v210, v211
    v_lshlrev_b32 v210, 16, v214
    v_and_b32 v211, s67, v214
    v_cvt_pk_bf16_f32 v214, v212, v213
    v_lshlrev_b32 v212, 16, v214
    v_and_b32 v213, s67, v214
    v_lshrrev_b32 v216, 4, v60
    v_lshlrev_b32 v216, 7, v216
    v_and_b32 v217, 3, v60
    v_lshl_add_u32 v216, v217, 5, v216
    v_add_u32 v216, 98304, v216
    v_lshlrev_b32 v214, 16, v192
    v_and_b32 v215, s67, v192
    v_mul_f32 v224, v210, v214
    v_mul_f32 v225, v210, v215
    v_lshlrev_b32 v214, 16, v193
    v_and_b32 v215, s67, v193
    v_mul_f32 v226, v210, v214
    v_mul_f32 v227, v210, v215
    v_lshlrev_b32 v214, 16, v194
    v_and_b32 v215, s67, v194
    v_mul_f32 v228, v210, v214
    v_mul_f32 v229, v210, v215
    v_lshlrev_b32 v214, 16, v195
    v_and_b32 v215, s67, v195
    v_mul_f32 v230, v210, v214
    v_mul_f32 v231, v210, v215
    v_lshlrev_b32 v214, 16, v196
    v_and_b32 v215, s67, v196
    v_fmac_f32 v224, v211, v214
    v_fmac_f32 v225, v211, v215
    v_lshlrev_b32 v214, 16, v197
    v_and_b32 v215, s67, v197
    v_fmac_f32 v226, v211, v214
    v_fmac_f32 v227, v211, v215
    v_lshlrev_b32 v214, 16, v198
    v_and_b32 v215, s67, v198
    v_fmac_f32 v228, v211, v214
    v_fmac_f32 v229, v211, v215
    v_lshlrev_b32 v214, 16, v199
    v_and_b32 v215, s67, v199
    v_fmac_f32 v230, v211, v214
    v_fmac_f32 v231, v211, v215
    v_lshlrev_b32 v214, 16, v200
    v_and_b32 v215, s67, v200
    v_fmac_f32 v224, v212, v214
    v_fmac_f32 v225, v212, v215
    v_lshlrev_b32 v214, 16, v201
    v_and_b32 v215, s67, v201
    v_fmac_f32 v226, v212, v214
    v_fmac_f32 v227, v212, v215
    v_lshlrev_b32 v214, 16, v202
    v_and_b32 v215, s67, v202
    v_fmac_f32 v228, v212, v214
    v_fmac_f32 v229, v212, v215
    v_lshlrev_b32 v214, 16, v203
    v_and_b32 v215, s67, v203
    v_fmac_f32 v230, v212, v214
    v_fmac_f32 v231, v212, v215
    v_lshlrev_b32 v214, 16, v204
    v_and_b32 v215, s67, v204
    v_fmac_f32 v224, v213, v214
    v_fmac_f32 v225, v213, v215
    v_lshlrev_b32 v214, 16, v205
    v_and_b32 v215, s67, v205
    v_fmac_f32 v226, v213, v214
    v_fmac_f32 v227, v213, v215
    v_lshlrev_b32 v214, 16, v206
    v_and_b32 v215, s67, v206
    v_fmac_f32 v228, v213, v214
    v_fmac_f32 v229, v213, v215
    v_lshlrev_b32 v214, 16, v207
    v_and_b32 v215, s67, v207
    v_fmac_f32 v230, v213, v214
    v_fmac_f32 v231, v213, v215
    v_add_f32_dpp v224, v224, v224 row_ror:4 row_mask:0xf bank_mask:0xf
    v_add_f32_dpp v225, v225, v225 row_ror:4 row_mask:0xf bank_mask:0xf
    v_add_f32_dpp v226, v226, v226 row_ror:4 row_mask:0xf bank_mask:0xf
    v_add_f32_dpp v227, v227, v227 row_ror:4 row_mask:0xf bank_mask:0xf
    v_add_f32_dpp v228, v228, v228 row_ror:4 row_mask:0xf bank_mask:0xf
    v_add_f32_dpp v229, v229, v229 row_ror:4 row_mask:0xf bank_mask:0xf
    v_add_f32_dpp v230, v230, v230 row_ror:4 row_mask:0xf bank_mask:0xf
    v_add_f32_dpp v231, v231, v231 row_ror:4 row_mask:0xf bank_mask:0xf
    v_add_f32_dpp v224, v224, v224 row_ror:8 row_mask:0xf bank_mask:0xf
    v_add_f32_dpp v225, v225, v225 row_ror:8 row_mask:0xf bank_mask:0xf
    v_add_f32_dpp v226, v226, v226 row_ror:8 row_mask:0xf bank_mask:0xf
    v_add_f32_dpp v227, v227, v227 row_ror:8 row_mask:0xf bank_mask:0xf
    v_add_f32_dpp v228, v228, v228 row_ror:8 row_mask:0xf bank_mask:0xf
    v_add_f32_dpp v229, v229, v229 row_ror:8 row_mask:0xf bank_mask:0xf
    v_add_f32_dpp v230, v230, v230 row_ror:8 row_mask:0xf bank_mask:0xf
    v_add_f32_dpp v231, v231, v231 row_ror:8 row_mask:0xf bank_mask:0xf
    ds_write_b128 v216, v[224:227]
    ds_write_b128 v216, v[228:231] offset:16
    s_waitcnt lgkmcnt(0)
    s_barrier
    s_cmp_lg_u32 s64, 1
    s_cbranch_scc1 K_gbbC
    v_and_b32 v214, 31, v0
    v_lshlrev_b32 v215, 2, v214
    v_lshrrev_b32 v216, 5, v0
    v_lshl_add_u32 v216, v216, 11, v215
    v_add_u32 v216, 98304, v216
    ds_read_b32 v232, v216 offset:0
    ds_read_b32 v233, v216 offset:128
    ds_read_b32 v234, v216 offset:256
    ds_read_b32 v235, v216 offset:384
    ds_read_b32 v236, v216 offset:512
    ds_read_b32 v237, v216 offset:640
    ds_read_b32 v238, v216 offset:768
    ds_read_b32 v239, v216 offset:896
    ds_read_b32 v240, v216 offset:1024
    ds_read_b32 v241, v216 offset:1152
    ds_read_b32 v242, v216 offset:1280
    ds_read_b32 v243, v216 offset:1408
    ds_read_b32 v244, v216 offset:1536
    ds_read_b32 v245, v216 offset:1664
    ds_read_b32 v246, v216 offset:1792
    ds_read_b32 v247, v216 offset:1920
    s_waitcnt lgkmcnt(0)
    v_pk_add_f32 v[232:233], v[232:233], v[240:241]
    v_pk_add_f32 v[234:235], v[234:235], v[242:243]
    v_pk_add_f32 v[236:237], v[236:237], v[244:245]
    v_pk_add_f32 v[238:239], v[238:239], v[246:247]
    v_pk_add_f32 v[232:233], v[232:233], v[236:237]
    v_pk_add_f32 v[234:235], v[234:235], v[238:239]
    v_pk_add_f32 v[232:233], v[232:233], v[234:235]
    v_add_f32 v232, v232, v233
    v_mov_b32 v233, v232
    s_nop 1
    v_permlane32_swap_b32 v232, v233
    v_add_f32 v232, v232, v233
    v_cvt_pk_bf16_f32 v232, v232, v232
    v_lshlrev_b32 v214, 1, v214
    v_add_u32 v214, 102400, v214
    ds_write_b16 v214, v232
    v_add_u32 v217, 102400, v220
    v_mov_b32 v235, 1
    s_waitcnt lgkmcnt(0)
    ds_read_b128 v[236:239], v217
    s_waitcnt lgkmcnt(0)
    v_mov_b32 v58, v221
K_gbbC:
    s_barrier
K_ngbC:
    buffer_store_dwordx4 v[236:239], v58, s[60:63], 0 offen sc1
    v_mov_b32 v24, 0
    v_lshlrev_b32 v25, 5, v0
    s_cmp_lg_u32 s64, 0
    s_cbranch_scc1 K_pa_skip
    v_readlane_b32 s73, v63, s65
    s_mov_b32 s71, 40000
K_pa:
    buffer_load_dword v22, v24, s[60:63], s35 offen sc1
    s_waitcnt vmcnt(0)
    v_readfirstlane_b32 s72, v22
    s_nop 0
    s_cmp_lg_u32 s72, s73
    s_cbranch_scc1 K_pad
    s_and_b32 s72, s71, 15
    s_cmp_lg_u32 s72, 7
    s_cbranch_scc1 K_pa2
    buffer_load_dword v22, v24, s[56:59], 0 offen sc1
    s_waitcnt vmcnt(0)
    v_readfirstlane_b32 s72, v22
    s_nop 0
    s_cmp_ge_u32 s72, 32
    s_cbranch_scc1 K_pad
K_pa2:
    s_sleep 2
    s_sub_u32 s71, s71, 1
    s_cmp_lg_u32 s71, 0
    s_cbranch_scc1 K_pa
K_pad:
    s_mov_b32 s71, 8192
    s_mov_b32 m0, 98304
    s_nop 0
    buffer_load_dwordx4 v21, s[60:63], s71 offen offset:0 sc1 lds
    buffer_load_dwordx4 v21, s[60:63], s71 offen offset:1024 sc1 lds
    buffer_load_dwordx4 v21, s[60:63], s71 offen offset:2048 sc1 lds
    buffer_load_dwordx4 v21, s[60:63], s71 offen offset:3072 sc1 lds
    s_waitcnt vmcnt(0)
K_pa_skip:
    s_barrier
    v_add_u32 v25, 98304, v25
    ds_read_b128 v[104:107], v25 offset:0
    ds_read_b128 v[108:111], v25 offset:16
    ds_read_b128 v[112:115], v25 offset:2048
    ds_read_b128 v[116:119], v25 offset:2064
    s_waitcnt lgkmcnt(0)
    s_barrier
    v_pk_fma_f32 v[128:129], v[128:129], v[112:113], v[104:105]
    v_pk_fma_f32 v[130:131], v[130:131], v[114:115], v[106:107]
    v_pk_fma_f32 v[132:133], v[132:133], v[116:117], v[108:109]
    v_pk_fma_f32 v[134:135], v[134:135], v[118:119], v[110:111]
    v_cvt_pk_bf16_f32 v80, v128, v129
    v_cvt_pk_bf16_f32 v81, v130, v131
    v_cvt_pk_bf16_f32 v82, v132, v133
    v_cvt_pk_bf16_f32 v83, v134, v135
    v_xor_b32 v22, 0, v38
    ds_write_b128 v22, v[80:83]
    v_pk_fma_f32 v[136:137], v[136:137], v[112:113], v[104:105]
    v_pk_fma_f32 v[138:139], v[138:139], v[114:115], v[106:107]
    v_pk_fma_f32 v[140:141], v[140:141], v[116:117], v[108:109]
    v_pk_fma_f32 v[142:143], v[142:143], v[118:119], v[110:111]
    v_cvt_pk_bf16_f32 v84, v136, v137
    v_cvt_pk_bf16_f32 v85, v138, v139
    v_cvt_pk_bf16_f32 v86, v140, v141
    v_cvt_pk_bf16_f32 v87, v142, v143
    v_xor_b32 v23, 16, v38
    ds_write_b128 v23, v[84:87]
    v_pk_fma_f32 v[144:145], v[144:145], v[112:113], v[104:105]
    v_pk_fma_f32 v[146:147], v[146:147], v[114:115], v[106:107]
    v_pk_fma_f32 v[148:149], v[148:149], v[116:117], v[108:109]
    v_pk_fma_f32 v[150:151], v[150:151], v[118:119], v[110:111]
    v_cvt_pk_bf16_f32 v88, v144, v145
    v_cvt_pk_bf16_f32 v89, v146, v147
    v_cvt_pk_bf16_f32 v90, v148, v149
    v_cvt_pk_bf16_f32 v91, v150, v151
    v_xor_b32 v22, 32, v38
    ds_write_b128 v22, v[88:91]
    v_pk_fma_f32 v[152:153], v[152:153], v[112:113], v[104:105]
    v_pk_fma_f32 v[154:155], v[154:155], v[114:115], v[106:107]
    v_pk_fma_f32 v[156:157], v[156:157], v[116:117], v[108:109]
    v_pk_fma_f32 v[158:159], v[158:159], v[118:119], v[110:111]
    v_cvt_pk_bf16_f32 v92, v152, v153
    v_cvt_pk_bf16_f32 v93, v154, v155
    v_cvt_pk_bf16_f32 v94, v156, v157
    v_cvt_pk_bf16_f32 v95, v158, v159
    v_xor_b32 v23, 48, v38
    ds_write_b128 v23, v[92:95]
    v_pk_fma_f32 v[160:161], v[160:161], v[112:113], v[104:105]
    v_pk_fma_f32 v[162:163], v[162:163], v[114:115], v[106:107]
    v_pk_fma_f32 v[164:165], v[164:165], v[116:117], v[108:109]
    v_pk_fma_f32 v[166:167], v[166:167], v[118:119], v[110:111]
    v_cvt_pk_bf16_f32 v80, v160, v161
    v_cvt_pk_bf16_f32 v81, v162, v163
    v_cvt_pk_bf16_f32 v82, v164, v165
    v_cvt_pk_bf16_f32 v83, v166, v167
    v_xor_b32 v22, 64, v38
    ds_write_b128 v22, v[80:83]
    v_pk_fma_f32 v[168:169], v[168:169], v[112:113], v[104:105]
    v_pk_fma_f32 v[170:171], v[170:171], v[114:115], v[106:107]
    v_pk_fma_f32 v[172:173], v[172:173], v[116:117], v[108:109]
    v_pk_fma_f32 v[174:175], v[174:175], v[118:119], v[110:111]
    v_cvt_pk_bf16_f32 v84, v168, v169
    v_cvt_pk_bf16_f32 v85, v170, v171
    v_cvt_pk_bf16_f32 v86, v172, v173
    v_cvt_pk_bf16_f32 v87, v174, v175
    v_xor_b32 v23, 80, v38
    ds_write_b128 v23, v[84:87]
    v_pk_fma_f32 v[176:177], v[176:177], v[112:113], v[104:105]
    v_pk_fma_f32 v[178:179], v[178:179], v[114:115], v[106:107]
    v_pk_fma_f32 v[180:181], v[180:181], v[116:117], v[108:109]
    v_pk_fma_f32 v[182:183], v[182:183], v[118:119], v[110:111]
    v_cvt_pk_bf16_f32 v88, v176, v177
    v_cvt_pk_bf16_f32 v89, v178, v179
    v_cvt_pk_bf16_f32 v90, v180, v181
    v_cvt_pk_bf16_f32 v91, v182, v183
    v_xor_b32 v22, 96, v38
    ds_write_b128 v22, v[88:91]
    v_pk_fma_f32 v[184:185], v[184:185], v[112:113], v[104:105]
    v_pk_fma_f32 v[186:187], v[186:187], v[114:115], v[106:107]
    v_pk_fma_f32 v[188:189], v[188:189], v[116:117], v[108:109]
    v_pk_fma_f32 v[190:191], v[190:191], v[118:119], v[110:111]
    v_cvt_pk_bf16_f32 v92, v184, v185
    v_cvt_pk_bf16_f32 v93, v186, v187
    v_cvt_pk_bf16_f32 v94, v188, v189
    v_cvt_pk_bf16_f32 v95, v190, v191
    v_xor_b32 v23, 112, v38
    ds_write_b128 v23, v[92:95]
    s_waitcnt lgkmcnt(0)
    s_barrier
    s_waitcnt vmcnt(12)
    ds_read_b64_tr_b16 v[160:161], v32 offset:0
    ds_read_b64_tr_b16 v[162:163], v32 offset:512
    ds_read_b64_tr_b16 v[164:165], v33 offset:0
    ds_read_b64_tr_b16 v[166:167], v33 offset:512
    ds_read_b128 v[168:171], v34 offset:0
    ds_read_b128 v[172:175], v34 offset:1024
    s_waitcnt vmcnt(10)
    ds_read_b64_tr_b16 v[176:177], v32 offset:2048
    ds_read_b64_tr_b16 v[178:179], v32 offset:2560
    ds_read_b64_tr_b16 v[180:181], v33 offset:2048
    ds_read_b64_tr_b16 v[182:183], v33 offset:2560
    ds_read_b128 v[184:187], v35 offset:2048
    ds_read_b128 v[188:191], v35 offset:3072
    s_waitcnt lgkmcnt(6)
    v_mfma_f32_32x32x16_bf16 v[192:207], v[160:163], v[168:171], 0
    s_add_u32 m0, s69, 0
    s_add_u32 s72, s70, 65536
    buffer_load_dwordx4 v16, s[44:47], s70 offen lds
    s_add_u32 m0, s69, 1024
    s_add_u32 s70, s70, 131072
    buffer_load_dwordx4 v16, s[44:47], s72 offen lds
    v_mfma_f32_32x32x16_bf16 v[208:223], v[164:167], v[168:171], 0
    v_mfma_f32_32x32x16_bf16 v[224:239], v[160:163], v[172:175], 0
    v_mfma_f32_32x32x16_bf16 v[240:255], v[164:167], v[172:175], 0
    s_lshl_b32 s71, s65, 3
    s_add_u32 s71, s71, s64
    s_lshl_b32 s71, s71, 9
    v_and_b32 v22, 3, v0
    v_lshlrev_b32 v22, 7, v22
    buffer_load_dword v31, v22, s[36:39], s71 offen
    buffer_load_dword v31, v22, s[40:43], s71 offen
    s_mov_b32 s48, s18
    s_mov_b32 s49, s19
    s_mov_b32 s50, 3584
    s_mov_b32 s51, 0x00020000
    v_lshlrev_b32 v22, 6, v0
    buffer_load_dword v31, v22, s[48:51], 0 offen
    s_mov_b32 s48, s22
    s_mov_b32 s49, s23
    s_mov_b32 s50, 1024
    s_mov_b32 s51, 0x00020000
    buffer_load_dword v31, v22, s[48:51], 0 offen
    s_waitcnt vmcnt(14)
    ds_read_b64_tr_b16 v[160:161], v32 offset:4096
    ds_read_b64_tr_b16 v[162:163], v32 offset:4608
    ds_read_b64_tr_b16 v[164:165], v33 offset:4096
    ds_read_b64_tr_b16 v[166:167], v33 offset:4608
    ds_read_b128 v[168:171], v36 offset:4096
    ds_read_b128 v[172:175], v36 offset:5120
    s_waitcnt lgkmcnt(6)
    v_mfma_f32_32x32x16_bf16 v[192:207], v[176:179], v[184:187], v[192:207]
    s_add_u32 m0, s69, 2048
    s_add_u32 s72, s70, 65536
    buffer_load_dwordx4 v16, s[44:47], s70 offen lds
    s_add_u32 m0, s69, 3072
    s_add_u32 s70, s70, 131072
    buffer_load_dwordx4 v16, s[44:47], s72 offen lds
    v_mfma_f32_32x32x16_bf16 v[208:223], v[180:183], v[184:187], v[208:223]
    v_mfma_f32_32x32x16_bf16 v[224:239], v[176:179], v[188:191], v[224:239]
    v_mfma_f32_32x32x16_bf16 v[240:255], v[180:183], v[188:191], v[240:255]
    s_waitcnt vmcnt(14)
    ds_read_b64_tr_b16 v[176:177], v32 offset:6144
    ds_read_b64_tr_b16 v[178:179], v32 offset:6656
    ds_read_b64_tr_b16 v[180:181], v33 offset:6144
    ds_read_b64_tr_b16 v[182:183], v33 offset:6656
    ds_read_b128 v[184:187], v37 offset:6144
    ds_read_b128 v[188:191], v37 offset:7168
    s_waitcnt lgkmcnt(6)
    v_mfma_f32_32x32x16_bf16 v[192:207], v[160:163], v[168:171], v[192:207]
    s_add_u32 m0, s69, 4096
    s_add_u32 s72, s70, 65536
    buffer_load_dwordx4 v16, s[44:47], s70 offen lds
    s_add_u32 m0, s69, 5120
    s_add_u32 s70, s70, 131072
    buffer_load_dwordx4 v16, s[44:47], s72 offen lds
    v_mfma_f32_32x32x16_bf16 v[208:223], v[164:167], v[168:171], v[208:223]
    v_mfma_f32_32x32x16_bf16 v[224:239], v[160:163], v[172:175], v[224:239]
    v_mfma_f32_32x32x16_bf16 v[240:255], v[164:167], v[172:175], v[240:255]
    v_lshlrev_b32 v22, 5, v0
    v_add_u32 v22, 256, v22
    v_cmp_gt_u32 vcc, 24, v0
    v_mov_b32 v23, 0x100000
    s_nop 0
    v_cndmask_b32 v22, v23, v22, vcc
    v_mov_b32 v23, 0
    s_lshl_b32 s71, s66, 2
    s_add_u32 s71, s71, s35
    s_cmp_lg_u32 s64, 1
    s_cselect_b32 s71, 0x100000, s71
    buffer_store_dword v23, v22, s[60:63], s71 offen sc1
    s_waitcnt vmcnt(15)
    ds_read_b64_tr_b16 v[160:161], v32 offset:8192
    ds_read_b64_tr_b16 v[162:163], v32 offset:8704
    ds_read_b64_tr_b16 v[164:165], v33 offset:8192
    ds_read_b64_tr_b16 v[166:167], v33 offset:8704
    ds_read_b128 v[168:171], v34 offset:8192
    ds_read_b128 v[172:175], v34 offset:9216
    s_waitcnt lgkmcnt(6)
    v_mfma_f32_32x32x16_bf16 v[192:207], v[176:179], v[184:187], v[192:207]
    s_add_u32 m0, s69, 6144
    s_add_u32 s72, s70, 65536
    buffer_load_dwordx4 v16, s[44:47], s70 offen lds
    s_add_u32 m0, s69, 7168
    s_add_u32 s70, s70, 131072
    buffer_load_dwordx4 v16, s[44:47], s72 offen lds
    v_mfma_f32_32x32x16_bf16 v[208:223], v[180:183], v[184:187], v[208:223]
    v_mfma_f32_32x32x16_bf16 v[224:239], v[176:179], v[188:191], v[224:239]
    v_mfma_f32_32x32x16_bf16 v[240:255], v[180:183], v[188:191], v[240:255]
    s_waitcnt vmcnt(15)
    ds_read_b64_tr_b16 v[176:177], v32 offset:10240
    ds_read_b64_tr_b16 v[178:179], v32 offset:10752
    ds_read_b64_tr_b16 v[180:181], v33 offset:10240
    ds_read_b64_tr_b16 v[182:183], v33 offset:10752
    ds_read_b128 v[184:187], v35 offset:10240
    ds_read_b128 v[188:191], v35 offset:11264
    s_waitcnt lgkmcnt(6)
    v_mfma_f32_32x32x16_bf16 v[192:207], v[160:163], v[168:171], v[192:207]
    s_add_u32 m0, s69, 8192
    s_add_u32 s72, s70, 65536
    buffer_load_dwordx4 v16, s[44:47], s70 offen lds
    s_add_u32 m0, s69, 9216
    s_add_u32 s70, s70, 131072
    buffer_load_dwordx4 v16, s[44:47], s72 offen lds
    v_mfma_f32_32x32x16_bf16 v[208:223], v[164:167], v[168:171], v[208:223]
    v_mfma_f32_32x32x16_bf16 v[224:239], v[160:163], v[172:175], v[224:239]
    v_mfma_f32_32x32x16_bf16 v[240:255], v[164:167], v[172:175], v[240:255]
    s_waitcnt vmcnt(13)
    ds_read_b64_tr_b16 v[160:161], v32 offset:0
    ds_read_b64_tr_b16 v[162:163], v32 offset:512
    ds_read_b64_tr_b16 v[164:165], v33 offset:0
    ds_read_b64_tr_b16 v[166:167], v33 offset:512
    ds_read_b128 v[168:171], v36 offset:12288
    ds_read_b128 v[172:175], v36 offset:13312
    s_waitcnt lgkmcnt(6)
    v_mfma_f32_32x32x16_bf16 v[192:207], v[176:179], v[184:187], v[192:207]
    s_add_u32 m0, s69, 10240
    s_add_u32 s72, s70, 65536
    buffer_load_dwordx4 v16, s[44:47], s70 offen lds
    s_add_u32 m0, s69, 11264
    s_add_u32 s70, s70, 131072
    buffer_load_dwordx4 v16, s[44:47], s72 offen lds
    v_mfma_f32_32x32x16_bf16 v[208:223], v[180:183], v[184:187], v[208:223]
    v_mfma_f32_32x32x16_bf16 v[224:239], v[176:179], v[188:191], v[224:239]
    v_mfma_f32_32x32x16_bf16 v[240:255], v[180:183], v[188:191], v[240:255]
    s_waitcnt vmcnt(9)
    ds_read_b64_tr_b16 v[176:177], v32 offset:2048
    ds_read_b64_tr_b16 v[178:179], v32 offset:2560
    ds_read_b64_tr_b16 v[180:181], v33 offset:2048
    ds_read_b64_tr_b16 v[182:183], v33 offset:2560
    ds_read_b128 v[184:187], v37 offset:14336
    ds_read_b128 v[188:191], v37 offset:15360
    s_waitcnt lgkmcnt(6)
    v_mfma_f32_32x32x16_bf16 v[192:207], v[160:163], v[168:171], v[192:207]
    s_add_u32 m0, s69, 0
    s_add_u32 s72, s70, 65536
    buffer_load_dwordx4 v16, s[44:47], s70 offen lds
    s_add_u32 m0, s69, 1024
    s_add_u32 s70, s70, 131072
    buffer_load_dwordx4 v16, s[44:47], s72 offen lds
    v_mfma_f32_32x32x16_bf16 v[208:223], v[164:167], v[168:171], v[208:223]
    v_mfma_f32_32x32x16_bf16 v[224:239], v[160:163], v[172:175], v[224:239]
    v_mfma_f32_32x32x16_bf16 v[240:255], v[164:167], v[172:175], v[240:255]
    s_waitcnt vmcnt(9)
    ds_read_b64_tr_b16 v[160:161], v32 offset:4096
    ds_read_b64_tr_b16 v[162:163], v32 offset:4608
    ds_read_b64_tr_b16 v[164:165], v33 offset:4096
    ds_read_b64_tr_b16 v[166:167], v33 offset:4608
    ds_read_b128 v[168:171], v34 offset:16384
    ds_read_b128 v[172:175], v34 offset:17408
    s_waitcnt lgkmcnt(6)
    v_mfma_f32_32x32x16_bf16 v[192:207], v[176:179], v[184:187], v[192:207]
    s_add_u32 m0, s69, 2048
    s_add_u32 s72, s70, 65536
    buffer_load_dwordx4 v16, s[44:47], s70 offen lds
    s_add_u32 m0, s69, 3072
    s_add_u32 s70, s70, 131072
    buffer_load_dwordx4 v16, s[44:47], s72 offen lds
    v_mfma_f32_32x32x16_bf16 v[208:223], v[180:183], v[184:187], v[208:223]
    v_mfma_f32_32x32x16_bf16 v[224:239], v[176:179], v[188:191], v[224:239]
    v_mfma_f32_32x32x16_bf16 v[240:255], v[180:183], v[188:191], v[240:255]
    s_waitcnt vmcnt(8)
    ds_read_b64_tr_b16 v[176:177], v32 offset:6144
    ds_read_b64_tr_b16 v[178:179], v32 offset:6656
    ds_read_b64_tr_b16 v[180:181], v33 offset:6144
    ds_read_b64_tr_b16 v[182:183], v33 offset:6656
    ds_read_b128 v[184:187], v35 offset:18432
    ds_read_b128 v[188:191], v35 offset:19456
    s_waitcnt lgkmcnt(6)
    v_mfma_f32_32x32x16_bf16 v[192:207], v[160:163], v[168:171], v[192:207]
    s_add_u32 m0, s69, 4096
    s_add_u32 s72, s70, 65536
    buffer_load_dwordx4 v16, s[44:47], s70 offen lds
    s_add_u32 m0, s69, 5120
    s_add_u32 s70, s70, 131072
    buffer_load_dwordx4 v16, s[44:47], s72 offen lds
    v_mfma_f32_32x32x16_bf16 v[208:223], v[164:167], v[168:171], v[208:223]
    v_mfma_f32_32x32x16_bf16 v[224:239], v[160:163], v[172:175], v[224:239]
    v_mfma_f32_32x32x16_bf16 v[240:255], v[164:167], v[172:175], v[240:255]
    s_waitcnt vmcnt(8)
    ds_read_b64_tr_b16 v[160:161], v32 offset:8192
    ds_read_b64_tr_b16 v[162:163], v32 offset:8704
    ds_read_b64_tr_b16 v[164:165], v33 offset:8192
    ds_read_b64_tr_b16 v[166:167], v33 offset:8704
    ds_read_b128 v[168:171], v36 offset:20480
    ds_read_b128 v[172:175], v36 offset:21504
    s_waitcnt lgkmcnt(6)
    v_mfma_f32_32x32x16_bf16 v[192:207], v[176:179], v[184:187], v[192:207]
    s_add_u32 m0, s69, 6144
    s_add_u32 s72, s70, 65536
    buffer_load_dwordx4 v16, s[44:47], s70 offen lds
    s_add_u32 m0, s69, 7168
    s_add_u32 s70, s70, 131072
    buffer_load_dwordx4 v16, s[44:47], s72 offen lds
    v_mfma_f32_32x32x16_bf16 v[208:223], v[180:183], v[184:187], v[208:223]
    v_mfma_f32_32x32x16_bf16 v[224:239], v[176:179], v[188:191], v[224:239]
    v_mfma_f32_32x32x16_bf16 v[240:255], v[180:183], v[188:191], v[240:255]
    s_waitcnt vmcnt(8)
    ds_read_b64_tr_b16 v[176:177], v32 offset:10240
    ds_read_b64_tr_b16 v[178:179], v32 offset:10752
    ds_read_b64_tr_b16 v[180:181], v33 offset:10240
    ds_read_b64_tr_b16 v[182:183], v33 offset:10752
    ds_read_b128 v[184:187], v37 offset:22528
    ds_read_b128 v[188:191], v37 offset:23552
    s_waitcnt lgkmcnt(6)
    v_mfma_f32_32x32x16_bf16 v[192:207], v[160:163], v[168:171], v[192:207]
    s_add_u32 m0, s69, 8192
    s_add_u32 s72, s70, 65536
    buffer_load_dwordx4 v16, s[44:47], s70 offen lds
    s_add_u32 m0, s69, 9216
    s_add_u32 s70, s70, 131072
    buffer_load_dwordx4 v16, s[44:47], s72 offen lds
    v_mfma_f32_32x32x16_bf16 v[208:223], v[164:167], v[168:171], v[208:223]
    v_mfma_f32_32x32x16_bf16 v[224:239], v[160:163], v[172:175], v[224:239]
    v_mfma_f32_32x32x16_bf16 v[240:255], v[164:167], v[172:175], v[240:255]
    s_waitcnt vmcnt(8)
    ds_read_b64_tr_b16 v[160:161], v32 offset:0
    ds_read_b64_tr_b16 v[162:163], v32 offset:512
    ds_read_b64_tr_b16 v[164:165], v33 offset:0
    ds_read_b64_tr_b16 v[166:167], v33 offset:512
    ds_read_b128 v[168:171], v34 offset:24576
    ds_read_b128 v[172:175], v34 offset:25600
    s_waitcnt lgkmcnt(6)
    v_mfma_f32_32x32x16_bf16 v[192:207], v[176:179], v[184:187], v[192:207]
    s_add_u32 m0, s69, 10240
    s_add_u32 s72, s70, 65536
    buffer_load_dwordx4 v16, s[44:47], s70 offen lds
    s_add_u32 m0, s69, 11264
    s_add_u32 s70, s70, 131072
    buffer_load_dwordx4 v16, s[44:47], s72 offen lds
    v_mfma_f32_32x32x16_bf16 v[208:223], v[180:183], v[184:187], v[208:223]
    v_mfma_f32_32x32x16_bf16 v[224:239], v[176:179], v[188:191], v[224:239]
    v_mfma_f32_32x32x16_bf16 v[240:255], v[180:183], v[188:191], v[240:255]
    s_barrier
    s_add_u32 m0, s68, 98304
    s_mov_b32 s71, 0
    buffer_load_dwordx4 v13, s[36:39], s71 offen lds
    buffer_load_dwordx4 v14, s[36:39], s71 offen offset:1024 lds
    s_waitcnt vmcnt(10)
    ds_read_b64_tr_b16 v[176:177], v32 offset:2048
    ds_read_b64_tr_b16 v[178:179], v32 offset:2560
    ds_read_b64_tr_b16 v[180:181], v33 offset:2048
    ds_read_b64_tr_b16 v[182:183], v33 offset:2560
    ds_read_b128 v[184:187], v35 offset:26624
    ds_read_b128 v[188:191], v35 offset:27648
    s_waitcnt lgkmcnt(6)
    v_mfma_f32_32x32x16_bf16 v[192:207], v[160:163], v[168:171], v[192:207]
    s_add_u32 m0, s69, 0
    s_add_u32 s72, s70, 65536
    buffer_load_dwordx4 v16, s[44:47], s70 offen lds
    s_add_u32 m0, s69, 1024
    s_add_u32 s70, s70, 131072
    buffer_load_dwordx4 v16, s[44:47], s72 offen lds
    v_mfma_f32_32x32x16_bf16 v[208:223], v[164:167], v[168:171], v[208:223]
    v_mfma_f32_32x32x16_bf16 v[224:239], v[160:163], v[172:175], v[224:239]
    v_mfma_f32_32x32x16_bf16 v[240:255], v[164:167], v[172:175], v[240:255]
    s_waitcnt vmcnt(10)
    ds_read_b64_tr_b16 v[160:161], v32 offset:4096
    ds_read_b64_tr_b16 v[162:163], v32 offset:4608
    ds_read_b64_tr_b16 v[164:165], v33 offset:4096
    ds_read_b64_tr_b16 v[166:167], v33 offset:4608
    ds_read_b128 v[168:171], v36 offset:28672
    ds_read_b128 v[172:175], v36 offset:29696
    s_waitcnt lgkmcnt(6)
    v_mfma_f32_32x32x16_bf16 v[192:207], v[176:179], v[184:187], v[192:207]
    s_add_u32 m0, s69, 2048
    s_add_u32 s72, s70, 65536
    buffer_load_dwordx4 v16, s[44:47], s70 offen lds
    s_add_u32 m0, s69, 3072
    s_add_u32 s70, s70, 131072
    buffer_load_dwordx4 v16, s[44:47], s72 offen lds
    v_mfma_f32_32x32x16_bf16 v[208:223], v[180:183], v[184:187], v[208:223]
    v_mfma_f32_32x32x16_bf16 v[224:239], v[176:179], v[188:191], v[224:239]
    v_mfma_f32_32x32x16_bf16 v[240:255], v[180:183], v[188:191], v[240:255]
    s_waitcnt vmcnt(10)
    ds_read_b64_tr_b16 v[176:177], v32 offset:6144
    ds_read_b64_tr_b16 v[178:179], v32 offset:6656
    ds_read_b64_tr_b16 v[180:181], v33 offset:6144
    ds_read_b64_tr_b16 v[182:183], v33 offset:6656
    ds_read_b128 v[184:187], v37 offset:30720
    ds_read_b128 v[188:191], v37 offset:31744
    s_waitcnt lgkmcnt(6)
    v_mfma_f32_32x32x16_bf16 v[192:207], v[160:163], v[168:171], v[192:207]
    s_add_u32 m0, s69, 4096
    s_add_u32 s72, s70, 65536
    buffer_load_dwordx4 v16, s[44:47], s70 offen lds
    s_add_u32 m0, s69, 5120
    s_add_u32 s70, s70, 131072
    buffer_load_dwordx4 v16, s[44:47], s72 offen lds
    v_mfma_f32_32x32x16_bf16 v[208:223], v[164:167], v[168:171], v[208:223]
    v_mfma_f32_32x32x16_bf16 v[224:239], v[160:163], v[172:175], v[224:239]
    v_mfma_f32_32x32x16_bf16 v[240:255], v[164:167], v[172:175], v[240:255]
    s_waitcnt vmcnt(10)
    ds_read_b64_tr_b16 v[160:161], v32 offset:8192
    ds_read_b64_tr_b16 v[162:163], v32 offset:8704
    ds_read_b64_tr_b16 v[164:165], v33 offset:8192
    ds_read_b64_tr_b16 v[166:167], v33 offset:8704
    ds_read_b128 v[168:171], v34 offset:32768
    ds_read_b128 v[172:175], v34 offset:33792
    s_waitcnt lgkmcnt(6)
    v_mfma_f32_32x32x16_bf16 v[192:207], v[176:179], v[184:187], v[192:207]
    s_add_u32 m0, s69, 6144
    s_add_u32 s72, s70, 65536
    buffer_load_dwordx4 v16, s[44:47], s70 offen lds
    s_add_u32 m0, s69, 7168
    s_add_u32 s70, s70, 131072
    buffer_load_dwordx4 v16, s[44:47], s72 offen lds
    v_mfma_f32_32x32x16_bf16 v[208:223], v[180:183], v[184:187], v[208:223]
    v_mfma_f32_32x32x16_bf16 v[224:239], v[176:179], v[188:191], v[224:239]
    v_mfma_f32_32x32x16_bf16 v[240:255], v[180:183], v[188:191], v[240:255]
    s_waitcnt vmcnt(10)
    ds_read_b64_tr_b16 v[176:177], v32 offset:10240
    ds_read_b64_tr_b16 v[178:179], v32 offset:10752
    ds_read_b64_tr_b16 v[180:181], v33 offset:10240
    ds_read_b64_tr_b16 v[182:183], v33 offset:10752
    ds_read_b128 v[184:187], v35 offset:34816
    ds_read_b128 v[188:191], v35 offset:35840
    s_waitcnt lgkmcnt(6)
    v_mfma_f32_32x32x16_bf16 v[192:207], v[160:163], v[168:171], v[192:207]
    s_add_u32 m0, s69, 8192
    s_add_u32 s72, s70, 65536
    buffer_load_dwordx4 v16, s[44:47], s70 offen lds
    s_add_u32 m0, s69, 9216
    s_add_u32 s70, s70, 131072
    buffer_load_dwordx4 v16, s[44:47], s72 offen lds
    v_mfma_f32_32x32x16_bf16 v[208:223], v[164:167], v[168:171], v[208:223]
    v_mfma_f32_32x32x16_bf16 v[224:239], v[160:163], v[172:175], v[224:239]
    v_mfma_f32_32x32x16_bf16 v[240:255], v[164:167], v[172:175], v[240:255]
    s_waitcnt vmcnt(8)
    ds_read_b64_tr_b16 v[160:161], v32 offset:0
    ds_read_b64_tr_b16 v[162:163], v32 offset:512
    ds_read_b64_tr_b16 v[164:165], v33 offset:0
    ds_read_b64_tr_b16 v[166:167], v33 offset:512
    ds_read_b128 v[168:171], v36 offset:36864
    ds_read_b128 v[172:175], v36 offset:37888
    s_waitcnt lgkmcnt(6)
    v_mfma_f32_32x32x16_bf16 v[192:207], v[176:179], v[184:187], v[192:207]
    s_add_u32 m0, s69, 10240
    s_add_u32 s72, s70, 65536
    buffer_load_dwordx4 v16, s[44:47], s70 offen lds
    s_add_u32 m0, s69, 11264
    s_add_u32 s70, s70, 131072
    buffer_load_dwordx4 v16, s[44:47], s72 offen lds
    v_mfma_f32_32x32x16_bf16 v[208:223], v[180:183], v[184:187], v[208:223]
    v_mfma_f32_32x32x16_bf16 v[224:239], v[176:179], v[188:191], v[224:239]
    v_mfma_f32_32x32x16_bf16 v[240:255], v[180:183], v[188:191], v[240:255]
    s_waitcnt vmcnt(8)
    ds_read_b64_tr_b16 v[176:177], v32 offset:2048
    ds_read_b64_tr_b16 v[178:179], v32 offset:2560
    ds_read_b64_tr_b16 v[180:181], v33 offset:2048
    ds_read_b64_tr_b16 v[182:183], v33 offset:2560
    ds_read_b128 v[184:187], v37 offset:38912
    ds_read_b128 v[188:191], v37 offset:39936
    s_waitcnt lgkmcnt(6)
    v_mfma_f32_32x32x16_bf16 v[192:207], v[160:163], v[168:171], v[192:207]
    s_add_u32 m0, s69, 0
    s_add_u32 s72, s70, 65536
    buffer_load_dwordx4 v16, s[44:47], s70 offen lds
    s_add_u32 m0, s69, 1024
    s_add_u32 s70, s70, 131072
    buffer_load_dwordx4 v16, s[44:47], s72 offen lds
    v_mfma_f32_32x32x16_bf16 v[208:223], v[164:167], v[168:171], v[208:223]
    v_mfma_f32_32x32x16_bf16 v[224:239], v[160:163], v[172:175], v[224:239]
    v_mfma_f32_32x32x16_bf16 v[240:255], v[164:167], v[172:175], v[240:255]
    s_waitcnt vmcnt(8)
    ds_read_b64_tr_b16 v[160:161], v32 offset:4096
    ds_read_b64_tr_b16 v[162:163], v32 offset:4608
    ds_read_b64_tr_b16 v[164:165], v33 offset:4096
    ds_read_b64_tr_b16 v[166:167], v33 offset:4608
    ds_read_b128 v[168:171], v34 offset:40960
    ds_read_b128 v[172:175], v34 offset:41984
    s_waitcnt lgkmcnt(6)
    v_mfma_f32_32x32x16_bf16 v[192:207], v[176:179], v[184:187], v[192:207]
    s_add_u32 m0, s69, 2048
    s_add_u32 s72, s70, 65536
    buffer_load_dwordx4 v16, s[44:47], s70 offen lds
    s_add_u32 m0, s69, 3072
    s_add_u32 s70, s70, 131072
    buffer_load_dwordx4 v16, s[44:47], s72 offen lds
    v_mfma_f32_32x32x16_bf16 v[208:223], v[180:183], v[184:187], v[208:223]
    v_mfma_f32_32x32x16_bf16 v[224:239], v[176:179], v[188:191], v[224:239]
    v_mfma_f32_32x32x16_bf16 v[240:255], v[180:183], v[188:191], v[240:255]
    s_waitcnt vmcnt(8)
    ds_read_b64_tr_b16 v[176:177], v32 offset:6144
    ds_read_b64_tr_b16 v[178:179], v32 offset:6656
    ds_read_b64_tr_b16 v[180:181], v33 offset:6144
    ds_read_b64_tr_b16 v[182:183], v33 offset:6656
    ds_read_b128 v[184:187], v35 offset:43008
    ds_read_b128 v[188:191], v35 offset:44032
    s_waitcnt lgkmcnt(6)
    v_mfma_f32_32x32x16_bf16 v[192:207], v[160:163], v[168:171], v[192:207]
    s_add_u32 m0, s69, 4096
    s_add_u32 s72, s70, 65536
    buffer_load_dwordx4 v16, s[44:47], s70 offen lds
    s_add_u32 m0, s69, 5120
    s_add_u32 s70, s70, 131072
    buffer_load_dwordx4 v16, s[44:47], s72 offen lds
    v_mfma_f32_32x32x16_bf16 v[208:223], v[164:167], v[168:171], v[208:223]
    v_mfma_f32_32x32x16_bf16 v[224:239], v[160:163], v[172:175], v[224:239]
    v_mfma_f32_32x32x16_bf16 v[240:255], v[164:167], v[172:175], v[240:255]
    s_waitcnt vmcnt(8)
    ds_read_b64_tr_b16 v[160:161], v32 offset:8192
    ds_read_b64_tr_b16 v[162:163], v32 offset:8704
    ds_read_b64_tr_b16 v[164:165], v33 offset:8192
    ds_read_b64_tr_b16 v[166:167], v33 offset:8704
    ds_read_b128 v[168:171], v36 offset:45056
    ds_read_b128 v[172:175], v36 offset:46080
    s_waitcnt lgkmcnt(6)
    v_mfma_f32_32x32x16_bf16 v[192:207], v[176:179], v[184:187], v[192:207]
    s_add_u32 m0, s69, 6144
    s_add_u32 s72, s70, 65536
    buffer_load_dwordx4 v16, s[44:47], s70 offen lds
    s_add_u32 m0, s69, 7168
    s_add_u32 s70, s70, 131072
    buffer_load_dwordx4 v16, s[44:47], s72 offen lds
    v_mfma_f32_32x32x16_bf16 v[208:223], v[180:183], v[184:187], v[208:223]
    v_mfma_f32_32x32x16_bf16 v[224:239], v[176:179], v[188:191], v[224:239]
    v_mfma_f32_32x32x16_bf16 v[240:255], v[180:183], v[188:191], v[240:255]
    s_waitcnt vmcnt(8)
    ds_read_b64_tr_b16 v[176:177], v32 offset:10240
    ds_read_b64_tr_b16 v[178:179], v32 offset:10752
    ds_read_b64_tr_b16 v[180:181], v33 offset:10240
    ds_read_b64_tr_b16 v[182:183], v33 offset:10752
    ds_read_b128 v[184:187], v37 offset:47104
    ds_read_b128 v[188:191], v37 offset:48128
    s_waitcnt lgkmcnt(6)
    v_mfma_f32_32x32x16_bf16 v[192:207], v[160:163], v[168:171], v[192:207]
    s_add_u32 m0, s69, 8192
    s_add_u32 s72, s70, 65536
    buffer_load_dwordx4 v16, s[44:47], s70 offen lds
    s_add_u32 m0, s69, 9216
    s_add_u32 s70, s70, 131072
    buffer_load_dwordx4 v16, s[44:47], s72 offen lds
    v_mfma_f32_32x32x16_bf16 v[208:223], v[164:167], v[168:171], v[208:223]
    v_mfma_f32_32x32x16_bf16 v[224:239], v[160:163], v[172:175], v[224:239]
    v_mfma_f32_32x32x16_bf16 v[240:255], v[164:167], v[172:175], v[240:255]
    s_waitcnt vmcnt(8)
    ds_read_b64_tr_b16 v[160:161], v32 offset:0
    ds_read_b64_tr_b16 v[162:163], v32 offset:512
    ds_read_b64_tr_b16 v[164:165], v33 offset:0
    ds_read_b64_tr_b16 v[166:167], v33 offset:512
    ds_read_b128 v[168:171], v34 offset:49152
    ds_read_b128 v[172:175], v34 offset:50176
    s_waitcnt lgkmcnt(6)
    v_mfma_f32_32x32x16_bf16 v[192:207], v[176:179], v[184:187], v[192:207]
    s_add_u32 m0, s69, 10240
    s_add_u32 s72, s70, 65536
    buffer_load_dwordx4 v16, s[44:47], s70 offen lds
    s_add_u32 m0, s69, 11264
    s_add_u32 s70, s70, 131072
    buffer_load_dwordx4 v16, s[44:47], s72 offen lds
    v_mfma_f32_32x32x16_bf16 v[208:223], v[180:183], v[184:187], v[208:223]
    v_mfma_f32_32x32x16_bf16 v[224:239], v[176:179], v[188:191], v[224:239]
    v_mfma_f32_32x32x16_bf16 v[240:255], v[180:183], v[188:191], v[240:255]
    s_waitcnt vmcnt(8)
    ds_read_b64_tr_b16 v[176:177], v32 offset:2048
    ds_read_b64_tr_b16 v[178:179], v32 offset:2560
    ds_read_b64_tr_b16 v[180:181], v33 offset:2048
    ds_read_b64_tr_b16 v[182:183], v33 offset:2560
    ds_read_b128 v[184:187], v35 offset:51200
    ds_read_b128 v[188:191], v35 offset:52224
    s_waitcnt lgkmcnt(6)
    v_mfma_f32_32x32x16_bf16 v[192:207], v[160:163], v[168:171], v[192:207]
    s_add_u32 m0, s69, 0
    s_add_u32 s72, s70, 65536
    buffer_load_dwordx4 v16, s[44:47], s70 offen lds
    s_add_u32 m0, s69, 1024
    s_add_u32 s70, s70, 131072
    buffer_load_dwordx4 v16, s[44:47], s72 offen lds
    v_mfma_f32_32x32x16_bf16 v[208:223], v[164:167], v[168:171], v[208:223]
    v_mfma_f32_32x32x16_bf16 v[224:239], v[160:163], v[172:175], v[224:239]
    v_mfma_f32_32x32x16_bf16 v[240:255], v[164:167], v[172:175], v[240:255]
    s_waitcnt vmcnt(8)
    ds_read_b64_tr_b16 v[160:161], v32 offset:4096
    ds_read_b64_tr_b16 v[162:163], v32 offset:4608
    ds_read_b64_tr_b16 v[164:165], v33 offset:4096
    ds_read_b64_tr_b16 v[166:167], v33 offset:4608
    ds_read_b128 v[168:171], v36 offset:53248
    ds_read_b128 v[172:175], v36 offset:54272
    s_waitcnt lgkmcnt(6)
    v_mfma_f32_32x32x16_bf16 v[192:207], v[176:179], v[184:187], v[192:207]
    s_add_u32 m0, s69, 2048
    s_add_u32 s72, s70, 65536
    buffer_load_dwordx4 v16, s[44:47], s70 offen lds
    s_add_u32 m0, s69, 3072
    s_add_u32 s70, s70, 131072
    buffer_load_dwordx4 v16, s[44:47], s72 offen lds
    v_mfma_f32_32x32x16_bf16 v[208:223], v[180:183], v[184:187], v[208:223]
    v_mfma_f32_32x32x16_bf16 v[224:239], v[176:179], v[188:191], v[224:239]
    v_mfma_f32_32x32x16_bf16 v[240:255], v[180:183], v[188:191], v[240:255]
    s_waitcnt vmcnt(8)
    ds_read_b64_tr_b16 v[176:177], v32 offset:6144
    ds_read_b64_tr_b16 v[178:179], v32 offset:6656
    ds_read_b64_tr_b16 v[180:181], v33 offset:6144
    ds_read_b64_tr_b16 v[182:183], v33 offset:6656
    ds_read_b128 v[184:187], v37 offset:55296
    ds_read_b128 v[188:191], v37 offset:56320
    s_waitcnt lgkmcnt(6)
    v_mfma_f32_32x32x16_bf16 v[192:207], v[160:163], v[168:171], v[192:207]
    v_mfma_f32_32x32x16_bf16 v[208:223], v[164:167], v[168:171], v[208:223]
    v_mfma_f32_32x32x16_bf16 v[224:239], v[160:163], v[172:175], v[224:239]
    v_mfma_f32_32x32x16_bf16 v[240:255], v[164:167], v[172:175], v[240:255]
    s_getreg_b32 s74, hwreg(HW_REG_XCC_ID, 0, 3)
    s_lshl_b32 s74, s74, 2
    s_lshl_b32 s71, 1, s74
    v_mov_b32 v22, s71
    s_lshl_b32 s75, s65, 2
    s_add_u32 s75, s75, 128
    s_cmp_lg_u32 s64, 1
    s_cselect_b32 s71, 0x100000, s75
    buffer_atomic_add v22, v39, s[56:59], s71 offen sc1
    s_sub_u32 s72, s2, 32
    s_cmp_lt_u32 s72, 64
    s_cselect_b32 s72, 4, 0x100000
    s_cmp_lg_u32 s64, 1
    s_cselect_b32 s72, 0x100000, s72
    v_mov_b32 v23, 1
    buffer_atomic_add v23, v39, s[56:59], s72 offen sc1
    s_waitcnt vmcnt(8)
    ds_read_b64_tr_b16 v[160:161], v32 offset:8192
    ds_read_b64_tr_b16 v[162:163], v32 offset:8704
    ds_read_b64_tr_b16 v[164:165], v33 offset:8192
    ds_read_b64_tr_b16 v[166:167], v33 offset:8704
    ds_read_b128 v[168:171], v34 offset:57344
    ds_read_b128 v[172:175], v34 offset:58368
    s_waitcnt lgkmcnt(6)
    v_mfma_f32_32x32x16_bf16 v[192:207], v[176:179], v[184:187], v[192:207]
    v_mfma_f32_32x32x16_bf16 v[208:223], v[180:183], v[184:187], v[208:223]
    v_mfma_f32_32x32x16_bf16 v[224:239], v[176:179], v[188:191], v[224:239]
    v_mfma_f32_32x32x16_bf16 v[240:255], v[180:183], v[188:191], v[240:255]
    s_waitcnt vmcnt(6)
    ds_read_b64_tr_b16 v[176:177], v32 offset:10240
    ds_read_b64_tr_b16 v[178:179], v32 offset:10752
    ds_read_b64_tr_b16 v[180:181], v33 offset:10240
    ds_read_b64_tr_b16 v[182:183], v33 offset:10752
    ds_read_b128 v[184:187], v35 offset:59392
    ds_read_b128 v[188:191], v35 offset:60416
    s_waitcnt lgkmcnt(6)
    v_mfma_f32_32x32x16_bf16 v[192:207], v[160:163], v[168:171], v[192:207]
    v_mfma_f32_32x32x16_bf16 v[208:223], v[164:167], v[168:171], v[208:223]
    v_mfma_f32_32x32x16_bf16 v[224:239], v[160:163], v[172:175], v[224:239]
    v_mfma_f32_32x32x16_bf16 v[240:255], v[164:167], v[172:175], v[240:255]
    s_waitcnt vmcnt(4)
    ds_read_b64_tr_b16 v[160:161], v32 offset:0
    ds_read_b64_tr_b16 v[162:163], v32 offset:512
    ds_read_b64_tr_b16 v[164:165], v33 offset:0
    ds_read_b64_tr_b16 v[166:167], v33 offset:512
    ds_read_b128 v[168:171], v36 offset:61440
    ds_read_b128 v[172:175], v36 offset:62464
    s_waitcnt lgkmcnt(6)
    v_mfma_f32_32x32x16_bf16 v[192:207], v[176:179], v[184:187], v[192:207]
    v_mfma_f32_32x32x16_bf16 v[208:223], v[180:183], v[184:187], v[208:223]
    v_mfma_f32_32x32x16_bf16 v[224:239], v[176:179], v[188:191], v[224:239]
    v_mfma_f32_32x32x16_bf16 v[240:255], v[180:183], v[188:191], v[240:255]
    s_waitcnt vmcnt(2)
    ds_read_b64_tr_b16 v[176:177], v32 offset:2048
    ds_read_b64_tr_b16 v[178:179], v32 offset:2560
    ds_read_b64_tr_b16 v[180:181], v33 offset:2048
    ds_read_b64_tr_b16 v[182:183], v33 offset:2560
    ds_read_b128 v[184:187], v37 offset:63488
    ds_read_b128 v[188:191], v37 offset:64512
    s_waitcnt lgkmcnt(6)
    v_mfma_f32_32x32x16_bf16 v[192:207], v[160:163], v[168:171], v[192:207]
    v_mfma_f32_32x32x16_bf16 v[208:223], v[164:167], v[168:171], v[208:223]
    v_mfma_f32_32x32x16_bf16 v[224:239], v[160:163], v[172:175], v[224:239]
    v_mfma_f32_32x32x16_bf16 v[240:255], v[164:167], v[172:175], v[240:255]
    s_waitcnt lgkmcnt(0)
    v_mfma_f32_32x32x16_bf16 v[192:207], v[176:179], v[184:187], v[192:207]
    v_mfma_f32_32x32x16_bf16 v[208:223], v[180:183], v[184:187], v[208:223]
    v_mfma_f32_32x32x16_bf16 v[224:239], v[176:179], v[188:191], v[224:239]
    v_mfma_f32_32x32x16_bf16 v[240:255], v[180:183], v[188:191], v[240:255]
    v_add_u32 v22, s69, v21
    s_nop 7
    v_cvt_pk_bf16_f32 v96, v192, v193
    v_cvt_pk_bf16_f32 v97, v194, v195
    v_cvt_pk_bf16_f32 v98, v196, v197
    v_cvt_pk_bf16_f32 v99, v198, v199
    ds_write_b128 v22, v[96:99] offset:0
    v_cvt_pk_bf16_f32 v100, v200, v201
    v_cvt_pk_bf16_f32 v101, v202, v203
    v_cvt_pk_bf16_f32 v102, v204, v205
    v_cvt_pk_bf16_f32 v103, v206, v207
    ds_write_b128 v22, v[100:103] offset:1024
    v_cvt_pk_bf16_f32 v104, v208, v209
    v_cvt_pk_bf16_f32 v105, v210, v211
    v_cvt_pk_bf16_f32 v106, v212, v213
    v_cvt_pk_bf16_f32 v107, v214, v215
    ds_write_b128 v22, v[104:107] offset:2048
    v_cvt_pk_bf16_f32 v108, v216, v217
    v_cvt_pk_bf16_f32 v109, v218, v219
    v_cvt_pk_bf16_f32 v110, v220, v221
    v_cvt_pk_bf16_f32 v111, v222, v223
    ds_write_b128 v22, v[108:111] offset:3072
    v_cvt_pk_bf16_f32 v112, v224, v225
    v_cvt_pk_bf16_f32 v113, v226, v227
    v_cvt_pk_bf16_f32 v114, v228, v229
    v_cvt_pk_bf16_f32 v115, v230, v231
    ds_write_b128 v22, v[112:115] offset:4096
    v_cvt_pk_bf16_f32 v116, v232, v233
    v_cvt_pk_bf16_f32 v117, v234, v235
    v_cvt_pk_bf16_f32 v118, v236, v237
    v_cvt_pk_bf16_f32 v119, v238, v239
    ds_write_b128 v22, v[116:119] offset:5120
    v_cvt_pk_bf16_f32 v120, v240, v241
    v_cvt_pk_bf16_f32 v121, v242, v243
    v_cvt_pk_bf16_f32 v122, v244, v245
    v_cvt_pk_bf16_f32 v123, v246, v247
    ds_write_b128 v22, v[120:123] offset:6144
    v_cvt_pk_bf16_f32 v124, v248, v249
    v_cvt_pk_bf16_f32 v125, v250, v251
    v_cvt_pk_bf16_f32 v126, v252, v253
    v_cvt_pk_bf16_f32 v127, v254, v255
    ds_write_b128 v22, v[124:127] offset:7168
    s_and_b32 s71, s64, 6
    s_mul_i32 s71, s71, 12288
    s_and_b32 s72, s64, 1
    s_lshl_b32 s72, s72, 12
    s_add_u32 s71, s71, s72
    v_add_u32 v22, s71, v21
    s_mov_b32 s44, s12
    s_mov_b32 s45, s13
    s_mov_b32 s46, 4194304
    s_mov_b32 s47, 0x00020000
    s_waitcnt vmcnt(30)
    s_waitcnt lgkmcnt(0)
    s_barrier
    ds_read_b128 v[160:163], v22 offset:0
    ds_read_b128 v[96:99], v5
    ds_read_b128 v[164:167], v22 offset:1024
    ds_read_b128 v[100:103], v6
    ds_read_b128 v[168:171], v22 offset:2048
    ds_read_b128 v[104:107], v7
    ds_read_b128 v[172:175], v22 offset:3072
    ds_read_b128 v[108:111], v8
    s_add_u32 m0, s68, 131072
    s_mov_b32 s71, 16384
    buffer_load_dwordx4 v13, s[36:39], s71 offen lds
    buffer_load_dwordx4 v14, s[36:39], s71 offen offset:1024 lds
    s_add_u32 m0, s68, 147456
    s_mov_b32 s71, 0
    buffer_load_dwordx4 v15, s[40:43], s71 offen lds
    buffer_load_dwordx4 v15, s[40:43], s71 offen offset:1024 lds
    ds_read_b128 v[176:179], v22 offset:12288
    ds_read_b128 v[112:115], v9
    ds_read_b128 v[180:183], v22 offset:13312
    ds_read_b128 v[116:119], v10
    ds_read_b128 v[184:187], v22 offset:14336
    ds_read_b128 v[120:123], v11
    ds_read_b128 v[188:191], v22 offset:15360
    ds_read_b128 v[124:127], v12
    s_waitcnt lgkmcnt(14)
    v_mfma_f32_32x32x16_bf16 v[32:47], v[96:99], v[160:163], 0
    ds_read_b128 v[128:131], v5 offset:8192
    v_pk_mov_b32 v[192:193], 0, 0
    v_pk_mov_b32 v[194:195], 0, 0
    v_pk_mov_b32 v[196:197], 0, 0
    v_pk_mov_b32 v[198:199], 0, 0
    s_waitcnt lgkmcnt(13)
    v_mfma_f32_32x32x16_bf16 v[32:47], v[100:103], v[164:167], v[32:47]
    ds_read_b128 v[132:135], v6 offset:8192
    v_pk_mov_b32 v[200:201], 0, 0
    v_pk_mov_b32 v[202:203], 0, 0
    v_pk_mov_b32 v[204:205], 0, 0
    v_pk_mov_b32 v[206:207], 0, 0
    s_waitcnt lgkmcnt(12)
    v_mfma_f32_32x32x16_bf16 v[32:47], v[104:107], v[168:171], v[32:47]
    ds_read_b128 v[136:139], v7 offset:8192
    v_pk_mov_b32 v[208:209], 0, 0
    v_pk_mov_b32 v[210:211], 0, 0
    v_pk_mov_b32 v[212:213], 0, 0
    v_pk_mov_b32 v[214:215], 0, 0
    s_waitcnt lgkmcnt(11)
    v_mfma_f32_32x32x16_bf16 v[32:47], v[108:111], v[172:175], v[32:47]
    ds_read_b128 v[140:143], v8 offset:8192
    v_pk_mov_b32 v[216:217], 0, 0
    v_pk_mov_b32 v[218:219], 0, 0
    v_pk_mov_b32 v[220:221], 0, 0
    v_pk_mov_b32 v[222:223], 0, 0
    s_waitcnt lgkmcnt(10)
    v_mfma_f32_32x32x16_bf16 v[32:47], v[112:115], v[176:179], v[32:47]
    ds_read_b128 v[144:147], v9 offset:8192
    v_pk_mov_b32 v[224:225], 0, 0
    v_pk_mov_b32 v[226:227], 0, 0
    v_pk_mov_b32 v[228:229], 0, 0
    v_pk_mov_b32 v[230:231], 0, 0
    s_waitcnt lgkmcnt(9)
    v_mfma_f32_32x32x16_bf16 v[32:47], v[116:119], v[180:183], v[32:47]
    ds_read_b128 v[148:151], v10 offset:8192
    v_pk_mov_b32 v[232:233], 0, 0
    v_pk_mov_b32 v[234:235], 0, 0
    v_pk_mov_b32 v[236:237], 0, 0
    v_pk_mov_b32 v[238:239], 0, 0
    s_waitcnt lgkmcnt(8)
    v_mfma_f32_32x32x16_bf16 v[32:47], v[120:123], v[184:187], v[32:47]
    ds_read_b128 v[152:155], v11 offset:8192
    v_pk_mov_b32 v[240:241], 0, 0
    v_pk_mov_b32 v[242:243], 0, 0
    v_pk_mov_b32 v[244:245], 0, 0
    v_pk_mov_b32 v[246:247], 0, 0
    s_waitcnt lgkmcnt(7)
    v_mfma_f32_32x32x16_bf16 v[32:47], v[124:127], v[188:191], v[32:47]
    ds_read_b128 v[156:159], v12 offset:8192
    v_pk_mov_b32 v[248:249], 0, 0
    v_pk_mov_b32 v[250:251], 0, 0
    v_pk_mov_b32 v[252:253], 0, 0
    v_pk_mov_b32 v[254:255], 0, 0
    s_barrier
    s_lshl_b32 s82, s65, 3
    s_add_u32 s82, s82, s64
    s_lshl_b32 s71, s65, 3
    s_add_u32 s71, s71, s66
    s_lshl_b32 s84, s71, 13
    s_add_u32 s84, s84, 16777216
    s_lshl_b32 s71, s71, 16
    s_lshl_b32 s83, s64, 13
    s_add_u32 s83, s83, s71
    s_mov_b32 s73, 1
    s_mov_b32 s81, 0x8000
    s_mov_b32 s76, 4
    s_mov_b32 s77, 65536
    s_mov_b32 s78, 65536
    s_mov_b32 s84, s83
    s_add_u32 s52, s32, 4194304
    s_addc_u32 s53, s33, 0
    s_mov_b32 s54, 16777216
    s_mov_b32 s55, 0x00020000
    s_add_u32 m0, s68, 0
    s_mov_b32 s71, 32768
    buffer_load_dwordx4 v13, s[36:39], s71 offen lds
    buffer_load_dwordx4 v14, s[36:39], s71 offen offset:1024 lds
    s_add_u32 m0, s68, 16384
    s_mov_b32 s71, 16384
    buffer_load_dwordx4 v15, s[40:43], s71 offen lds
    buffer_load_dwordx4 v15, s[40:43], s71 offen offset:1024 lds
    s_add_u32 m0, s68, 32768
    s_mov_b32 s71, 49152
    buffer_load_dwordx4 v13, s[36:39], s71 offen lds
    buffer_load_dwordx4 v14, s[36:39], s71 offen offset:1024 lds
    s_add_u32 m0, s68, 49152
    s_mov_b32 s71, 32768
    buffer_load_dwordx4 v15, s[40:43], s71 offen lds
    buffer_load_dwordx4 v15, s[40:43], s71 offen offset:1024 lds
    s_mul_i32 s71, s82, 7168
    s_mul_i32 s72, s66, 448
    s_add_u32 s71, s71, s72
    v_lshrrev_b32 v27, 5, v0
    v_mul_u32_u24 v27, 3584, v27
    v_and_b32 v24, 31, v0
    v_lshl_add_u32 v27, v24, 4, v27
    s_mov_b32 s48, s16
    s_mov_b32 s49, s17
    s_mov_b32 s50, 1835008
    s_mov_b32 s51, 0x00020000
    buffer_load_dwordx4 v[28:31], v27, s[48:51], s71 offen
    s_mul_i32 s71, s82, 896
    s_mul_i32 s72, s66, 229376
    s_add_u32 s71, s71, s72
    s_mov_b32 s48, s20
    s_mov_b32 s49, s21
    s_mov_b32 s50, 1835008
    s_mov_b32 s51, 0x00020000
    buffer_load_dwordx4 v[28:31], v21, s[48:51], s71 offen
    s_lshl_b32 s82, s82, 9
    s_lshl_b32 s72, s66, 19
    s_add_u32 s82, s82, s72
    s_add_u32 s82, s82, 0
    v_lshlrev_b32 v27, 3, v0
    v_mov_b32 v17, 0
    v_mov_b32 v18, 0
    v_mov_b32 v19, 0
    v_mov_b32 v20, 0
    v_max3_f32 v22, v32, v33, v34
    v_max3_f32 v23, v35, v36, v37
    v_max3_f32 v22, v22, v38, v39
    v_max3_f32 v23, v23, v40, v41
    v_max3_f32 v22, v22, v42, v43
    v_max3_f32 v23, v23, v44, v45
    v_max3_f32 v22, v22, v46, v47
    v_max_f32 v22, v22, v23
    v_mov_b32 v23, v22
    s_nop 1
    v_permlane32_swap_b32 v22, v23
    v_max_f32 v22, v22, v23
    v_pk_mul_f32 v[80:81], v[22:23], -1.0 op_sel_hi:[0,0]
    v_pk_mul_f32 v[82:83], v[22:23], -1.0 op_sel_hi:[0,0]
    v_pk_mul_f32 v[84:85], v[22:23], -1.0 op_sel_hi:[0,0]
    v_pk_mul_f32 v[86:87], v[22:23], -1.0 op_sel_hi:[0,0]
    v_pk_mul_f32 v[88:89], v[22:23], -1.0 op_sel_hi:[0,0]
    v_pk_mul_f32 v[90:91], v[22:23], -1.0 op_sel_hi:[0,0]
    v_pk_mul_f32 v[92:93], v[22:23], -1.0 op_sel_hi:[0,0]
    v_pk_mul_f32 v[94:95], v[22:23], -1.0 op_sel_hi:[0,0]
    v_pk_add_f32 v[32:33], v[32:33], v[22:23] op_sel_hi:[1,0] neg_lo:[0,1] neg_hi:[0,1]
    v_pk_add_f32 v[34:35], v[34:35], v[22:23] op_sel_hi:[1,0] neg_lo:[0,1] neg_hi:[0,1]
    v_pk_add_f32 v[36:37], v[36:37], v[22:23] op_sel_hi:[1,0] neg_lo:[0,1] neg_hi:[0,1]
    v_pk_add_f32 v[38:39], v[38:39], v[22:23] op_sel_hi:[1,0] neg_lo:[0,1] neg_hi:[0,1]
    v_pk_add_f32 v[40:41], v[40:41], v[22:23] op_sel_hi:[1,0] neg_lo:[0,1] neg_hi:[0,1]
    v_pk_add_f32 v[42:43], v[42:43], v[22:23] op_sel_hi:[1,0] neg_lo:[0,1] neg_hi:[0,1]
    v_pk_add_f32 v[44:45], v[44:45], v[22:23] op_sel_hi:[1,0] neg_lo:[0,1] neg_hi:[0,1]
    v_pk_add_f32 v[46:47], v[46:47], v[22:23] op_sel_hi:[1,0] neg_lo:[0,1] neg_hi:[0,1]
    s_waitcnt lgkmcnt(0)
    v_mfma_f32_32x32x16_bf16 v[48:63], v[128:131], v[160:163], v[80:95]
    v_add_u32 v5, 0x8000, v5
    v_exp_f32 v32, v32
    v_exp_f32 v33, v33
    v_add_f32 v17, v17, v32
    v_mfma_f32_32x32x16_bf16 v[48:63], v[132:135], v[164:167], v[48:63]
    v_add_u32 v6, 0x8000, v6
    v_exp_f32 v34, v34
    v_add_f32 v18, v18, v33
    v_cvt_pk_bf16_f32 v64, v32, v33
    v_exp_f32 v35, v35
    v_add_f32 v19, v19, v34
    v_mfma_f32_32x32x16_bf16 v[48:63], v[136:139], v[168:171], v[48:63]
    v_add_u32 v7, 0x8000, v7
    v_exp_f32 v36, v36
    v_add_f32 v20, v20, v35
    v_cvt_pk_bf16_f32 v65, v34, v35
    v_exp_f32 v37, v37
    v_add_f32 v17, v17, v36
    v_mfma_f32_32x32x16_bf16 v[48:63], v[140:143], v[172:175], v[48:63]
    v_add_u32 v8, 0x8000, v8
    v_exp_f32 v38, v38
    v_add_f32 v18, v18, v37
    v_cvt_pk_bf16_f32 v66, v36, v37
    v_exp_f32 v39, v39
    v_add_f32 v19, v19, v38
    v_mfma_f32_32x32x16_bf16 v[48:63], v[144:147], v[176:179], v[48:63]
    v_add_u32 v9, 0x8000, v9
    v_exp_f32 v40, v40
    v_add_f32 v20, v20, v39
    v_cvt_pk_bf16_f32 v67, v38, v39
    v_exp_f32 v41, v41
    v_add_f32 v17, v17, v40
    v_mfma_f32_32x32x16_bf16 v[48:63], v[148:151], v[180:183], v[48:63]
    v_add_u32 v10, 0x8000, v10
    v_exp_f32 v42, v42
    v_add_f32 v18, v18, v41
    v_cvt_pk_bf16_f32 v68, v40, v41
    v_exp_f32 v43, v43
    v_add_f32 v19, v19, v42
    v_mfma_f32_32x32x16_bf16 v[48:63], v[152:155], v[184:187], v[48:63]
    v_add_u32 v11, 0x8000, v11
    v_exp_f32 v44, v44
    v_add_f32 v20, v20, v43
    v_cvt_pk_bf16_f32 v69, v42, v43
    v_exp_f32 v45, v45
    v_add_f32 v17, v17, v44
    v_mfma_f32_32x32x16_bf16 v[48:63], v[156:159], v[188:191], v[48:63]
    v_add_u32 v12, 0x8000, v12
    v_exp_f32 v46, v46
    v_add_f32 v18, v18, v45
    v_cvt_pk_bf16_f32 v70, v44, v45
    v_exp_f32 v47, v47
    v_add_f32 v19, v19, v46
    v_add_f32 v20, v20, v47
    v_cvt_pk_bf16_f32 v71, v46, v47
    s_waitcnt vmcnt(10)
    s_barrier
    ds_read_b128 v[96:99], v5
    ds_read_b128 v[100:103], v6
    ds_read_b128 v[104:107], v7
    ds_read_b128 v[108:111], v8
K_loop:
    s_add_u32 s76, s76, 1
    s_cmp_eq_u32 s76, 5
    s_cselect_b32 s80, 0xfffe0000, s81
    s_cselect_b32 s76, 0, s76
    s_waitcnt lgkmcnt(3)
    v_mfma_f32_32x32x16_bf16 v[32:47], v[96:99], v[160:163], v[80:95]
    ds_read_b128 v[112:115], v9 offset:0
    v_exp_f32 v48, v48
    s_waitcnt lgkmcnt(3)
    v_mfma_f32_32x32x16_bf16 v[32:47], v[100:103], v[164:167], v[32:47]
    ds_read_b128 v[116:119], v10 offset:0
    s_cmp_ge_u32 s73, 6
    s_cbranch_scc1 adaLN_cond__sliding_block_cached__dense_activation_squared_relu__prompt_kernel_pc1
    s_add_u32 m0, s68, s77
    s_nop 0
    buffer_load_dwordx4 v13, s[36:39], s78 offen lds
adaLN_cond__sliding_block_cached__dense_activation_squared_relu__prompt_kernel_pc1:
    v_exp_f32 v49, v49
    v_add_f32 v17, v17, v48
    s_waitcnt lgkmcnt(3)
    v_mfma_f32_32x32x16_bf16 v[32:47], v[104:107], v[168:171], v[32:47]
    ds_read_b128 v[120:123], v11 offset:0
    v_exp_f32 v50, v50
    v_add_f32 v18, v18, v49
    v_cvt_pk_bf16_f32 v72, v48, v49
    s_waitcnt lgkmcnt(3)
    v_mfma_f32_32x32x16_bf16 v[32:47], v[108:111], v[172:175], v[32:47]
    ds_read_b128 v[124:127], v12 offset:0
    s_cmp_ge_u32 s73, 6
    s_cbranch_scc1 adaLN_cond__sliding_block_cached__dense_activation_squared_relu__prompt_kernel_pc2
    buffer_load_dwordx4 v14, s[36:39], s78 offen offset:1024 lds
    s_add_u32 m0, m0, 16384
    s_sub_u32 s79, s78, 16384
adaLN_cond__sliding_block_cached__dense_activation_squared_relu__prompt_kernel_pc2:
    v_exp_f32 v51, v51
    v_add_f32 v19, v19, v50
    s_waitcnt lgkmcnt(3)
    v_mfma_f32_32x32x16_bf16 v[32:47], v[112:115], v[176:179], v[32:47]
    ds_read_b64_tr_b16 v[128:129], v1 offset:16384
    ds_read_b64_tr_b16 v[130:131], v1 offset:17408
    v_exp_f32 v52, v52
    v_add_f32 v20, v20, v51
    v_cvt_pk_bf16_f32 v73, v50, v51
    s_waitcnt lgkmcnt(4)
    v_mfma_f32_32x32x16_bf16 v[32:47], v[116:119], v[180:183], v[32:47]
    ds_read_b64_tr_b16 v[132:133], v2 offset:16384
    ds_read_b64_tr_b16 v[134:135], v2 offset:17408
    s_cmp_ge_u32 s73, 6
    s_cbranch_scc1 adaLN_cond__sliding_block_cached__dense_activation_squared_relu__prompt_kernel_pc3
    buffer_load_dwordx4 v15, s[40:43], s79 offen lds
adaLN_cond__sliding_block_cached__dense_activation_squared_relu__prompt_kernel_pc3:
    v_exp_f32 v53, v53
    v_add_f32 v17, v17, v52
    s_waitcnt lgkmcnt(5)
    v_mfma_f32_32x32x16_bf16 v[32:47], v[120:123], v[184:187], v[32:47]
    ds_read_b64_tr_b16 v[136:137], v3 offset:16384
    ds_read_b64_tr_b16 v[138:139], v3 offset:17408
    v_exp_f32 v54, v54
    v_add_f32 v18, v18, v53
    v_cvt_pk_bf16_f32 v74, v52, v53
    s_waitcnt lgkmcnt(6)
    v_mfma_f32_32x32x16_bf16 v[32:47], v[124:127], v[188:191], v[32:47]
    ds_read_b64_tr_b16 v[140:141], v4 offset:16384
    ds_read_b64_tr_b16 v[142:143], v4 offset:17408
    s_cmp_ge_u32 s73, 6
    s_cbranch_scc1 adaLN_cond__sliding_block_cached__dense_activation_squared_relu__prompt_kernel_pc4
    buffer_load_dwordx4 v15, s[40:43], s79 offen offset:1024 lds
    s_add_u32 s77, s77, 0x8000
    s_cmp_eq_u32 s77, 0x28000
    s_cselect_b32 s77, 0, s77
    s_add_u32 s78, s78, 16384
adaLN_cond__sliding_block_cached__dense_activation_squared_relu__prompt_kernel_pc4:
    v_exp_f32 v55, v55
    v_add_f32 v19, v19, v54
    s_waitcnt lgkmcnt(6)
    v_mfma_f32_32x32x16_bf16 v[192:207], v[128:131], v[64:67], v[192:207]
    ds_read_b64_tr_b16 v[144:145], v1 offset:20480
    ds_read_b64_tr_b16 v[146:147], v1 offset:21504
    v_exp_f32 v56, v56
    v_add_f32 v20, v20, v55
    v_cvt_pk_bf16_f32 v75, v54, v55
    s_waitcnt lgkmcnt(6)
    v_mfma_f32_32x32x16_bf16 v[208:223], v[132:135], v[64:67], v[208:223]
    ds_read_b64_tr_b16 v[148:149], v2 offset:20480
    ds_read_b64_tr_b16 v[150:151], v2 offset:21504
    s_cmp_ge_u32 s73, 6
    s_cbranch_scc1 adaLN_cond__sliding_block_cached__dense_activation_squared_relu__prompt_kernel_pc5
    buffer_load_dwordx2 v[28:29], v27, s[44:47], s82 offen
    s_add_u32 s82, s82, 131072
    s_cmp_eq_u32 s73, 5
    s_cselect_b32 s84, 0x2000000, s84
adaLN_cond__sliding_block_cached__dense_activation_squared_relu__prompt_kernel_pc5:
    v_exp_f32 v57, v57
    v_add_f32 v17, v17, v56
    s_waitcnt lgkmcnt(6)
    v_mfma_f32_32x32x16_bf16 v[224:239], v[136:139], v[64:67], v[224:239]
    ds_read_b64_tr_b16 v[152:153], v3 offset:20480
    ds_read_b64_tr_b16 v[154:155], v3 offset:21504
    v_exp_f32 v58, v58
    v_add_f32 v18, v18, v57
    v_cvt_pk_bf16_f32 v76, v56, v57
    s_waitcnt lgkmcnt(6)
    v_mfma_f32_32x32x16_bf16 v[240:255], v[140:143], v[64:67], v[240:255]
    ds_read_b64_tr_b16 v[156:157], v4 offset:20480
    ds_read_b64_tr_b16 v[158:159], v4 offset:21504
    s_cmp_ge_u32 s73, 6
    s_cbranch_scc1 adaLN_cond__sliding_block_cached__dense_activation_squared_relu__prompt_kernel_pc6
    buffer_store_dwordx4 v[160:163], v21, s[52:55], s84 offen sc1
adaLN_cond__sliding_block_cached__dense_activation_squared_relu__prompt_kernel_pc6:
    v_exp_f32 v59, v59
    v_add_f32 v19, v19, v58
    s_waitcnt lgkmcnt(6)
    v_mfma_f32_32x32x16_bf16 v[192:207], v[144:147], v[68:71], v[192:207]
    ds_read_b128 v[96:99], v5 offset:8192
    v_exp_f32 v60, v60
    v_add_f32 v20, v20, v59
    v_cvt_pk_bf16_f32 v77, v58, v59
    s_waitcnt lgkmcnt(5)
    v_mfma_f32_32x32x16_bf16 v[208:223], v[148:151], v[68:71], v[208:223]
    ds_read_b128 v[100:103], v6 offset:8192
    s_cmp_ge_u32 s73, 6
    s_cbranch_scc1 adaLN_cond__sliding_block_cached__dense_activation_squared_relu__prompt_kernel_pc7
    buffer_store_dwordx4 v[160:163], v21, s[52:55], s84 offen offset:1024 sc1
    s_add_u32 s84, s84, 2048
adaLN_cond__sliding_block_cached__dense_activation_squared_relu__prompt_kernel_pc7:
    v_exp_f32 v61, v61
    v_add_f32 v17, v17, v60
    s_waitcnt lgkmcnt(4)
    v_mfma_f32_32x32x16_bf16 v[224:239], v[152:155], v[68:71], v[224:239]
    ds_read_b128 v[104:107], v7 offset:8192
    v_exp_f32 v62, v62
    v_add_f32 v18, v18, v61
    v_cvt_pk_bf16_f32 v78, v60, v61
    s_waitcnt lgkmcnt(3)
    v_mfma_f32_32x32x16_bf16 v[240:255], v[156:159], v[68:71], v[240:255]
    ds_read_b128 v[108:111], v8 offset:8192
    v_exp_f32 v63, v63
    v_add_f32 v19, v19, v62
    v_add_f32 v20, v20, v63
    v_cvt_pk_bf16_f32 v79, v62, v63
    s_waitcnt lgkmcnt(3)
    v_mfma_f32_32x32x16_bf16 v[48:63], v[96:99], v[160:163], v[80:95]
    ds_read_b128 v[112:115], v9 offset:8192
    v_exp_f32 v32, v32
    s_waitcnt lgkmcnt(3)
    v_mfma_f32_32x32x16_bf16 v[48:63], v[100:103], v[164:167], v[48:63]
    ds_read_b128 v[116:119], v10 offset:8192
    v_exp_f32 v33, v33
    v_add_f32 v17, v17, v32
    s_waitcnt lgkmcnt(3)
    v_mfma_f32_32x32x16_bf16 v[48:63], v[104:107], v[168:171], v[48:63]
    ds_read_b128 v[120:123], v11 offset:8192
    v_exp_f32 v34, v34
    v_add_f32 v18, v18, v33
    v_cvt_pk_bf16_f32 v64, v32, v33
    s_waitcnt lgkmcnt(3)
    v_mfma_f32_32x32x16_bf16 v[48:63], v[108:111], v[172:175], v[48:63]
    ds_read_b128 v[124:127], v12 offset:8192
    v_exp_f32 v35, v35
    v_add_f32 v19, v19, v34
    s_waitcnt lgkmcnt(3)
    v_mfma_f32_32x32x16_bf16 v[48:63], v[112:115], v[176:179], v[48:63]
    ds_read_b64_tr_b16 v[128:129], v1 offset:24576
    ds_read_b64_tr_b16 v[130:131], v1 offset:25600
    v_add_u32 v5, s80, v5
    v_exp_f32 v36, v36
    v_add_f32 v20, v20, v35
    v_cvt_pk_bf16_f32 v65, v34, v35
    s_waitcnt lgkmcnt(4)
    v_mfma_f32_32x32x16_bf16 v[48:63], v[116:119], v[180:183], v[48:63]
    ds_read_b64_tr_b16 v[132:133], v2 offset:24576
    ds_read_b64_tr_b16 v[134:135], v2 offset:25600
    v_add_u32 v6, s80, v6
    v_exp_f32 v37, v37
    v_add_f32 v17, v17, v36
    s_waitcnt lgkmcnt(5)
    v_mfma_f32_32x32x16_bf16 v[48:63], v[120:123], v[184:187], v[48:63]
    ds_read_b64_tr_b16 v[136:137], v3 offset:24576
    ds_read_b64_tr_b16 v[138:139], v3 offset:25600
    v_add_u32 v7, s80, v7
    v_exp_f32 v38, v38
    v_add_f32 v18, v18, v37
    v_cvt_pk_bf16_f32 v66, v36, v37
    s_waitcnt lgkmcnt(6)
    v_mfma_f32_32x32x16_bf16 v[48:63], v[124:127], v[188:191], v[48:63]
    ds_read_b64_tr_b16 v[140:141], v4 offset:24576
    ds_read_b64_tr_b16 v[142:143], v4 offset:25600
    v_add_u32 v8, s80, v8
    v_exp_f32 v39, v39
    v_add_f32 v19, v19, v38
    s_waitcnt lgkmcnt(6)
    v_mfma_f32_32x32x16_bf16 v[192:207], v[128:131], v[72:75], v[192:207]
    ds_read_b64_tr_b16 v[144:145], v1 offset:28672
    ds_read_b64_tr_b16 v[146:147], v1 offset:29696
    v_add_u32 v9, s80, v9
    v_exp_f32 v40, v40
    v_add_f32 v20, v20, v39
    v_cvt_pk_bf16_f32 v67, v38, v39
    s_waitcnt lgkmcnt(6)
    v_mfma_f32_32x32x16_bf16 v[208:223], v[132:135], v[72:75], v[208:223]
    ds_read_b64_tr_b16 v[148:149], v2 offset:28672
    ds_read_b64_tr_b16 v[150:151], v2 offset:29696
    v_add_u32 v10, s80, v10
    v_exp_f32 v41, v41
    v_add_f32 v17, v17, v40
    s_waitcnt lgkmcnt(6)
    v_mfma_f32_32x32x16_bf16 v[224:239], v[136:139], v[72:75], v[224:239]
    ds_read_b64_tr_b16 v[152:153], v3 offset:28672
    ds_read_b64_tr_b16 v[154:155], v3 offset:29696
    v_add_u32 v11, s80, v11
    v_exp_f32 v42, v42
    v_add_f32 v18, v18, v41
    v_cvt_pk_bf16_f32 v68, v40, v41
    s_waitcnt lgkmcnt(6)
    v_mfma_f32_32x32x16_bf16 v[240:255], v[140:143], v[72:75], v[240:255]
    ds_read_b64_tr_b16 v[156:157], v4 offset:28672
    ds_read_b64_tr_b16 v[158:159], v4 offset:29696
    v_add_u32 v12, s80, v12
    v_exp_f32 v43, v43
    v_add_f32 v19, v19, v42
    s_waitcnt lgkmcnt(6)
    v_mfma_f32_32x32x16_bf16 v[192:207], v[144:147], v[76:79], v[192:207]
    s_cmp_ge_u32 s73, 6
    s_cbranch_scc1 K_tailw
    s_waitcnt vmcnt(13)
    s_branch K_tail2
K_tailw:
    s_cmp_gt_u32 s73, 6
    s_cbranch_scc1 K_tail2
    s_waitcnt vmcnt(0)
K_tail2:
    s_barrier
    ds_read_b128 v[96:99], v5 offset:0
    v_add_u32 v1, s80, v1
    v_exp_f32 v44, v44
    v_add_f32 v20, v20, v43
    v_cvt_pk_bf16_f32 v69, v42, v43
    s_waitcnt lgkmcnt(5)
    v_mfma_f32_32x32x16_bf16 v[208:223], v[148:151], v[76:79], v[208:223]
    ds_read_b128 v[100:103], v6 offset:0
    v_add_u32 v2, s80, v2
    v_exp_f32 v45, v45
    v_add_f32 v17, v17, v44
    s_waitcnt lgkmcnt(4)
    v_mfma_f32_32x32x16_bf16 v[224:239], v[152:155], v[76:79], v[224:239]
    ds_read_b128 v[104:107], v7 offset:0
    v_add_u32 v3, s80, v3
    v_exp_f32 v46, v46
    v_add_f32 v18, v18, v45
    v_cvt_pk_bf16_f32 v70, v44, v45
    s_waitcnt lgkmcnt(3)
    v_mfma_f32_32x32x16_bf16 v[240:255], v[156:159], v[76:79], v[240:255]
    ds_read_b128 v[108:111], v8 offset:0
    v_add_u32 v4, s80, v4
    v_exp_f32 v47, v47
    v_add_f32 v19, v19, v46
    v_add_f32 v20, v20, v47
    v_cvt_pk_bf16_f32 v71, v46, v47
    s_add_u32 s73, s73, 1
    s_cmp_lt_u32 s73, 8
    s_cbranch_scc1 K_loop
    v_lshrrev_b32 v22, 3, v0
    v_and_b32 v23, 7, v0
    v_bfe_u32 v24, v0, 4, 1
    v_lshlrev_b32 v24, 2, v24
    v_xor_b32 v23, v23, v24
    v_lshlrev_b32 v23, 4, v23
    v_mul_u32_u24 v16, 1024, v22
    v_add_u32 v16, v16, v23
    s_add_u32 s69, s69, 0x10000
    s_mul_i32 s85, s66, 524288
    s_lshl_b32 s71, s64, 7
    s_add_u32 s85, s85, s71
    s_mov_b32 s70, s85
    ds_read_b64_tr_b16 v[128:129], v1 offset:16384
    ds_read_b64_tr_b16 v[130:131], v1 offset:17408
    ds_read_b64_tr_b16 v[132:133], v2 offset:16384
    ds_read_b64_tr_b16 v[134:135], v2 offset:17408
    ds_read_b64_tr_b16 v[136:137], v3 offset:16384
    ds_read_b64_tr_b16 v[138:139], v3 offset:17408
    ds_read_b64_tr_b16 v[140:141], v4 offset:16384
    ds_read_b64_tr_b16 v[142:143], v4 offset:17408
    s_waitcnt lgkmcnt(6)
    v_mfma_f32_32x32x16_bf16 v[192:207], v[128:131], v[64:67], v[192:207]
    ds_read_b64_tr_b16 v[144:145], v1 offset:20480
    ds_read_b64_tr_b16 v[146:147], v1 offset:21504
    s_add_u32 m0, s69, 0
    s_add_u32 s72, s70, 8192
    buffer_load_dwordx4 v16, s[44:47], s70 offen lds
    s_add_u32 m0, s69, 1024
    s_add_u32 s70, s70, 16384
    buffer_load_dwordx4 v16, s[44:47], s72 offen lds
    v_exp_f32 v48, v48
    v_exp_f32 v49, v49
    v_add_f32 v17, v17, v48
    s_waitcnt lgkmcnt(6)
    v_mfma_f32_32x32x16_bf16 v[208:223], v[132:135], v[64:67], v[208:223]
    ds_read_b64_tr_b16 v[148:149], v2 offset:20480
    ds_read_b64_tr_b16 v[150:151], v2 offset:21504
    s_add_u32 m0, s69, 2048
    s_add_u32 s72, s70, 8192
    buffer_load_dwordx4 v16, s[44:47], s70 offen lds
    s_add_u32 m0, s69, 3072
    s_add_u32 s70, s70, 16384
    buffer_load_dwordx4 v16, s[44:47], s72 offen lds
    v_exp_f32 v50, v50
    v_add_f32 v18, v18, v49
    v_cvt_pk_bf16_f32 v72, v48, v49
    v_exp_f32 v51, v51
    v_add_f32 v19, v19, v50
    s_waitcnt lgkmcnt(6)
    v_mfma_f32_32x32x16_bf16 v[224:239], v[136:139], v[64:67], v[224:239]
    ds_read_b64_tr_b16 v[152:153], v3 offset:20480
    ds_read_b64_tr_b16 v[154:155], v3 offset:21504
    s_add_u32 m0, s69, 4096
    s_add_u32 s72, s70, 8192
    buffer_load_dwordx4 v16, s[44:47], s70 offen lds
    s_add_u32 m0, s69, 5120
    s_add_u32 s70, s70, 16384
    buffer_load_dwordx4 v16, s[44:47], s72 offen lds
    v_exp_f32 v52, v52
    v_add_f32 v20, v20, v51
    v_cvt_pk_bf16_f32 v73, v50, v51
    v_exp_f32 v53, v53
    v_add_f32 v17, v17, v52
    s_waitcnt lgkmcnt(6)
    v_mfma_f32_32x32x16_bf16 v[240:255], v[140:143], v[64:67], v[240:255]
    ds_read_b64_tr_b16 v[156:157], v4 offset:20480
    ds_read_b64_tr_b16 v[158:159], v4 offset:21504
    s_add_u32 m0, s69, 6144
    s_add_u32 s72, s70, 8192
    buffer_load_dwordx4 v16, s[44:47], s70 offen lds
    s_add_u32 m0, s69, 7168
    s_add_u32 s70, s70, 16384
    buffer_load_dwordx4 v16, s[44:47], s72 offen lds
    v_exp_f32 v54, v54
    v_add_f32 v18, v18, v53
    v_cvt_pk_bf16_f32 v74, v52, v53
    v_exp_f32 v55, v55
    v_add_f32 v19, v19, v54
    s_waitcnt lgkmcnt(6)
    v_mfma_f32_32x32x16_bf16 v[192:207], v[144:147], v[68:71], v[192:207]
    ds_read_b64_tr_b16 v[128:129], v1 offset:24576
    ds_read_b64_tr_b16 v[130:131], v1 offset:25600
    s_add_u32 m0, s69, 8192
    s_add_u32 s72, s70, 8192
    buffer_load_dwordx4 v16, s[44:47], s70 offen lds
    s_add_u32 m0, s69, 9216
    s_add_u32 s70, s70, 16384
    buffer_load_dwordx4 v16, s[44:47], s72 offen lds
    v_exp_f32 v56, v56
    v_add_f32 v20, v20, v55
    v_cvt_pk_bf16_f32 v75, v54, v55
    v_exp_f32 v57, v57
    v_add_f32 v17, v17, v56
    s_waitcnt lgkmcnt(6)
    v_mfma_f32_32x32x16_bf16 v[208:223], v[148:151], v[68:71], v[208:223]
    ds_read_b64_tr_b16 v[144:145], v1 offset:28672
    ds_read_b64_tr_b16 v[146:147], v1 offset:29696
    s_add_u32 m0, s69, 10240
    s_add_u32 s72, s70, 8192
    buffer_load_dwordx4 v16, s[44:47], s70 offen lds
    s_add_u32 m0, s69, 11264
    s_add_u32 s70, s70, 16384
    buffer_load_dwordx4 v16, s[44:47], s72 offen lds
    v_exp_f32 v58, v58
    v_add_f32 v18, v18, v57
    v_cvt_pk_bf16_f32 v76, v56, v57
    v_exp_f32 v59, v59
    v_add_f32 v19, v19, v58
    s_waitcnt lgkmcnt(6)
    v_mfma_f32_32x32x16_bf16 v[224:239], v[152:155], v[68:71], v[224:239]
    ds_read_b64_tr_b16 v[132:133], v2 offset:24576
    ds_read_b64_tr_b16 v[134:135], v2 offset:25600
    v_exp_f32 v60, v60
    v_add_f32 v20, v20, v59
    v_cvt_pk_bf16_f32 v77, v58, v59
    v_exp_f32 v61, v61
    v_add_f32 v17, v17, v60
    s_waitcnt lgkmcnt(6)
    v_mfma_f32_32x32x16_bf16 v[240:255], v[156:159], v[68:71], v[240:255]
    ds_read_b64_tr_b16 v[148:149], v2 offset:28672
    ds_read_b64_tr_b16 v[150:151], v2 offset:29696
    v_exp_f32 v62, v62
    v_add_f32 v18, v18, v61
    v_cvt_pk_bf16_f32 v78, v60, v61
    v_exp_f32 v63, v63
    v_add_f32 v19, v19, v62
    v_add_f32 v20, v20, v63
    v_cvt_pk_bf16_f32 v79, v62, v63
    s_waitcnt lgkmcnt(6)
    v_mfma_f32_32x32x16_bf16 v[192:207], v[128:131], v[72:75], v[192:207]
    ds_read_b64_tr_b16 v[136:137], v3 offset:24576
    ds_read_b64_tr_b16 v[138:139], v3 offset:25600
    v_add_f32 v22, v17, v18
    v_add_f32 v23, v19, v20
    v_add_f32 v22, v22, v23
    v_mov_b32 v23, v22
    s_nop 1
    v_permlane32_swap_b32 v22, v23
    v_add_f32 v23, v22, v23
    v_rcp_f32 v22, v23
    s_waitcnt lgkmcnt(6)
    v_mfma_f32_32x32x16_bf16 v[192:207], v[144:147], v[76:79], v[192:207]
    ds_read_b64_tr_b16 v[152:153], v3 offset:28672
    ds_read_b64_tr_b16 v[154:155], v3 offset:29696
    v_lshrrev_b32 v24, 5, v0
    v_bfe_u32 v25, v0, 2, 2
    v_bfe_u32 v26, v0, 4, 1
    v_lshlrev_b32 v26, 5, v26
    v_and_b32 v27, 1, v0
    v_lshl_add_u32 v26, v27, 4, v26
    v_bfe_u32 v27, v0, 1, 1
    v_lshl_add_u32 v26, v27, 3, v26
    v_lshl_add_u32 v27, v24, 3, v25
    v_lshl_add_u32 v27, v27, 7, v26
    v_add_u32 v27, s69, v27
    v_lshrrev_b32 v28, 1, v25
    v_lshl_add_u32 v32, v28, 6, v27
    v_xor_b32 v33, 64, v32
    s_waitcnt lgkmcnt(6)
    v_mfma_f32_32x32x16_bf16 v[208:223], v[132:135], v[72:75], v[208:223]
    ds_read_b64_tr_b16 v[140:141], v4 offset:24576
    ds_read_b64_tr_b16 v[142:143], v4 offset:25600
    s_lshr_b32 s71, s64, 1
    s_lshl_b32 s71, s71, 14
    s_and_b32 s72, s64, 1
    s_lshl_b32 s72, s72, 10
    s_add_u32 s71, s71, s72
    v_add_u32 v34, s71, v21
    s_mov_b32 s71, 1820327936
    v_cmp_ngt_f32 vcc, s71, v23
    s_nop 0
    s_cmp_lg_u64 vcc, 0
    s_cbranch_scc1 K_slow
    s_waitcnt lgkmcnt(6)
    v_mfma_f32_32x32x16_bf16 v[208:223], v[148:151], v[76:79], v[208:223]
    ds_read_b64_tr_b16 v[156:157], v4 offset:28672
    ds_read_b64_tr_b16 v[158:159], v4 offset:29696
    s_waitcnt lgkmcnt(6)
    v_mfma_f32_32x32x16_bf16 v[224:239], v[136:139], v[72:75], v[224:239]
    v_pk_mul_f32 v[192:193], v[192:193], v[22:23] op_sel_hi:[1,0]
    v_pk_mul_f32 v[194:195], v[194:195], v[22:23] op_sel_hi:[1,0]
    v_pk_mul_f32 v[196:197], v[196:197], v[22:23] op_sel_hi:[1,0]
    v_pk_mul_f32 v[198:199], v[198:199], v[22:23] op_sel_hi:[1,0]
    v_cvt_pk_bf16_f32 v96, v192, v193
    v_cvt_pk_bf16_f32 v97, v194, v195
    v_cvt_pk_bf16_f32 v98, v196, v197
    v_cvt_pk_bf16_f32 v99, v198, v199
    v_pk_mul_f32 v[200:201], v[200:201], v[22:23] op_sel_hi:[1,0]
    v_pk_mul_f32 v[202:203], v[202:203], v[22:23] op_sel_hi:[1,0]
    v_pk_mul_f32 v[204:205], v[204:205], v[22:23] op_sel_hi:[1,0]
    v_pk_mul_f32 v[206:207], v[206:207], v[22:23] op_sel_hi:[1,0]
    v_cvt_pk_bf16_f32 v100, v200, v201
    v_cvt_pk_bf16_f32 v101, v202, v203
    v_cvt_pk_bf16_f32 v102, v204, v205
    v_cvt_pk_bf16_f32 v103, v206, v207
    s_waitcnt lgkmcnt(4)
    v_mfma_f32_32x32x16_bf16 v[224:239], v[152:155], v[76:79], v[224:239]
    s_waitcnt lgkmcnt(2)
    v_mfma_f32_32x32x16_bf16 v[240:255], v[140:143], v[72:75], v[240:255]
    v_pk_mul_f32 v[208:209], v[208:209], v[22:23] op_sel_hi:[1,0]
    v_pk_mul_f32 v[210:211], v[210:211], v[22:23] op_sel_hi:[1,0]
    v_pk_mul_f32 v[212:213], v[212:213], v[22:23] op_sel_hi:[1,0]
    v_pk_mul_f32 v[214:215], v[214:215], v[22:23] op_sel_hi:[1,0]
    v_cvt_pk_bf16_f32 v104, v208, v209
    v_cvt_pk_bf16_f32 v105, v210, v211
    v_cvt_pk_bf16_f32 v106, v212, v213
    v_cvt_pk_bf16_f32 v107, v214, v215
    v_pk_mul_f32 v[216:217], v[216:217], v[22:23] op_sel_hi:[1,0]
    v_pk_mul_f32 v[218:219], v[218:219], v[22:23] op_sel_hi:[1,0]
    v_pk_mul_f32 v[220:221], v[220:221], v[22:23] op_sel_hi:[1,0]
    v_pk_mul_f32 v[222:223], v[222:223], v[22:23] op_sel_hi:[1,0]
    v_cvt_pk_bf16_f32 v108, v216, v217
    v_cvt_pk_bf16_f32 v109, v218, v219
    v_cvt_pk_bf16_f32 v110, v220, v221
    v_cvt_pk_bf16_f32 v111, v222, v223
    s_waitcnt lgkmcnt(0)
    v_mfma_f32_32x32x16_bf16 v[240:255], v[156:159], v[76:79], v[240:255]
    v_pk_mul_f32 v[224:225], v[224:225], v[22:23] op_sel_hi:[1,0]
    v_pk_mul_f32 v[226:227], v[226:227], v[22:23] op_sel_hi:[1,0]
    v_pk_mul_f32 v[228:229], v[228:229], v[22:23] op_sel_hi:[1,0]
    v_pk_mul_f32 v[230:231], v[230:231], v[22:23] op_sel_hi:[1,0]
    v_cvt_pk_bf16_f32 v112, v224, v225
    v_cvt_pk_bf16_f32 v113, v226, v227
    v_cvt_pk_bf16_f32 v114, v228, v229
    v_cvt_pk_bf16_f32 v115, v230, v231
    v_pk_mul_f32 v[232:233], v[232:233], v[22:23] op_sel_hi:[1,0]
    v_pk_mul_f32 v[234:235], v[234:235], v[22:23] op_sel_hi:[1,0]
    v_pk_mul_f32 v[236:237], v[236:237], v[22:23] op_sel_hi:[1,0]
    v_pk_mul_f32 v[238:239], v[238:239], v[22:23] op_sel_hi:[1,0]
    v_cvt_pk_bf16_f32 v116, v232, v233
    v_cvt_pk_bf16_f32 v117, v234, v235
    v_cvt_pk_bf16_f32 v118, v236, v237
    v_cvt_pk_bf16_f32 v119, v238, v239
    v_pk_mul_f32 v[240:241], v[240:241], v[22:23] op_sel_hi:[1,0]
    v_pk_mul_f32 v[242:243], v[242:243], v[22:23] op_sel_hi:[1,0]
    v_pk_mul_f32 v[244:245], v[244:245], v[22:23] op_sel_hi:[1,0]
    v_pk_mul_f32 v[246:247], v[246:247], v[22:23] op_sel_hi:[1,0]
    v_cvt_pk_bf16_f32 v120, v240, v241
    v_cvt_pk_bf16_f32 v121, v242, v243
    v_cvt_pk_bf16_f32 v122, v244, v245
    v_cvt_pk_bf16_f32 v123, v246, v247
    v_pk_mul_f32 v[248:249], v[248:249], v[22:23] op_sel_hi:[1,0]
    v_pk_mul_f32 v[250:251], v[250:251], v[22:23] op_sel_hi:[1,0]
    v_pk_mul_f32 v[252:253], v[252:253], v[22:23] op_sel_hi:[1,0]
    v_pk_mul_f32 v[254:255], v[254:255], v[22:23] op_sel_hi:[1,0]
    v_cvt_pk_bf16_f32 v124, v248, v249
    v_cvt_pk_bf16_f32 v125, v250, v251
    v_cvt_pk_bf16_f32 v126, v252, v253
    v_cvt_pk_bf16_f32 v127, v254, v255
K_fin:
    s_barrier
    ds_write_b128 v34, v[96:99] offset:0
    ds_write_b128 v34, v[100:103] offset:2048
    ds_write_b128 v34, v[104:107] offset:4096
    ds_write_b128 v34, v[108:111] offset:6144
    ds_write_b128 v34, v[112:115] offset:8192
    ds_write_b128 v34, v[116:119] offset:10240
    ds_write_b128 v34, v[120:123] offset:12288
    ds_write_b128 v34, v[124:127] offset:14336
    s_waitcnt lgkmcnt(0)
    s_barrier
    v_mov_b32 v31, s75
    v_cmp_eq_u32 vcc, 0, v0
    s_nop 1
    v_cndmask_b32 v31, v31, 4, vcc
    buffer_load_dword v29, v31, s[56:59], 0 offen sc1
    s_waitcnt vmcnt(11)
    ds_read_b64_tr_b16 v[160:161], v32 offset:0
    ds_read_b64_tr_b16 v[162:163], v32 offset:512
    ds_read_b64_tr_b16 v[164:165], v33 offset:0
    ds_read_b64_tr_b16 v[166:167], v33 offset:512
    ds_read_b128 v[168:171], v21 offset:0
    ds_read_b128 v[172:175], v21 offset:1024
    s_waitcnt vmcnt(9)
    ds_read_b64_tr_b16 v[176:177], v32 offset:2048
    ds_read_b64_tr_b16 v[178:179], v32 offset:2560
    ds_read_b64_tr_b16 v[180:181], v33 offset:2048
    ds_read_b64_tr_b16 v[182:183], v33 offset:2560
    ds_read_b128 v[184:187], v21 offset:2048
    ds_read_b128 v[188:191], v21 offset:3072
    s_waitcnt lgkmcnt(6)
    v_mfma_f32_32x32x16_bf16 v[192:207], v[160:163], v[168:171], 0
    s_add_u32 m0, s69, 0
    s_add_u32 s72, s70, 8192
    buffer_load_dwordx4 v16, s[44:47], s70 offen lds
    s_add_u32 m0, s69, 1024
    s_add_u32 s70, s70, 16384
    buffer_load_dwordx4 v16, s[44:47], s72 offen lds
    v_mfma_f32_32x32x16_bf16 v[208:223], v[164:167], v[168:171], 0
    v_mfma_f32_32x32x16_bf16 v[224:239], v[160:163], v[172:175], 0
    v_mfma_f32_32x32x16_bf16 v[240:255], v[164:167], v[172:175], 0
    v_lshrrev_b32 v22, 3, v0
    s_lshl_b32 s71, s64, 3
    v_add_u32 v22, s71, v22
    v_and_b32 v23, 7, v0
    v_lshlrev_b32 v40, 9, v22
    v_lshl_add_u32 v40, v23, 4, v40
    s_lshl_b32 s71, s65, 16
    s_lshr_b32 s72, s66, 2
    s_lshl_b32 s72, s72, 15
    s_add_u32 s71, s71, s72
    s_and_b32 s72, s66, 3
    s_lshl_b32 s72, s72, 7
    s_add_u32 s71, s71, s72
    v_add_u32 v40, s71, v40
    v_lshlrev_b32 v42, 4, v22
    v_lshl_add_u32 v41, v23, 10, v42
    s_lshl_b32 s71, s65, 16
    s_lshl_b32 s72, s66, 13
    s_add_u32 s71, s71, s72
    v_add_u32 v41, s71, v41
    s_mov_b32 s36, s20
    s_mov_b32 s37, s21
    s_mov_b32 s38, 1835008
    s_mov_b32 s39, 0x00020000
    s_mul_i32 s84, s64, 229376
    s_mul_i32 s71, s66, 128
    s_add_u32 s84, s84, s71
    s_lshl_b32 s80, s64, 12
    s_add_u32 s80, s80, 8192
    s_waitcnt vmcnt(9)
    ds_read_b64_tr_b16 v[160:161], v32 offset:4096
    ds_read_b64_tr_b16 v[162:163], v32 offset:4608
    ds_read_b64_tr_b16 v[164:165], v33 offset:4096
    ds_read_b64_tr_b16 v[166:167], v33 offset:4608
    ds_read_b128 v[168:171], v21 offset:4096
    ds_read_b128 v[172:175], v21 offset:5120
    s_waitcnt lgkmcnt(6)
    v_mfma_f32_32x32x16_bf16 v[192:207], v[176:179], v[184:187], v[192:207]
    s_add_u32 m0, s69, 2048
    s_add_u32 s72, s70, 8192
    buffer_load_dwordx4 v16, s[44:47], s70 offen lds
    s_add_u32 m0, s69, 3072
    s_add_u32 s70, s70, 16384
    buffer_load_dwordx4 v16, s[44:47], s72 offen lds
    v_mfma_f32_32x32x16_bf16 v[208:223], v[180:183], v[184:187], v[208:223]
    v_mfma_f32_32x32x16_bf16 v[224:239], v[176:179], v[188:191], v[224:239]
    v_mfma_f32_32x32x16_bf16 v[240:255], v[180:183], v[188:191], v[240:255]
    s_waitcnt vmcnt(9)
    ds_read_b64_tr_b16 v[176:177], v32 offset:6144
    ds_read_b64_tr_b16 v[178:179], v32 offset:6656
    ds_read_b64_tr_b16 v[180:181], v33 offset:6144
    ds_read_b64_tr_b16 v[182:183], v33 offset:6656
    ds_read_b128 v[184:187], v21 offset:6144
    ds_read_b128 v[188:191], v21 offset:7168
    s_waitcnt lgkmcnt(6)
    v_mfma_f32_32x32x16_bf16 v[192:207], v[160:163], v[168:171], v[192:207]
    s_add_u32 m0, s69, 4096
    s_add_u32 s72, s70, 8192
    buffer_load_dwordx4 v16, s[44:47], s70 offen lds
    s_add_u32 m0, s69, 5120
    s_add_u32 s70, s70, 16384
    buffer_load_dwordx4 v16, s[44:47], s72 offen lds
    v_mfma_f32_32x32x16_bf16 v[208:223], v[164:167], v[168:171], v[208:223]
    v_mfma_f32_32x32x16_bf16 v[224:239], v[160:163], v[172:175], v[224:239]
    v_mfma_f32_32x32x16_bf16 v[240:255], v[164:167], v[172:175], v[240:255]
    s_waitcnt vmcnt(9)
    ds_read_b64_tr_b16 v[160:161], v32 offset:8192
    ds_read_b64_tr_b16 v[162:163], v32 offset:8704
    ds_read_b64_tr_b16 v[164:165], v33 offset:8192
    ds_read_b64_tr_b16 v[166:167], v33 offset:8704
    ds_read_b128 v[168:171], v21 offset:8192
    ds_read_b128 v[172:175], v21 offset:9216
    s_waitcnt lgkmcnt(6)
    v_mfma_f32_32x32x16_bf16 v[192:207], v[176:179], v[184:187], v[192:207]
    s_add_u32 m0, s69, 6144
    s_add_u32 s72, s70, 8192
    buffer_load_dwordx4 v16, s[44:47], s70 offen lds
    s_add_u32 m0, s69, 7168
    s_add_u32 s70, s70, 16384
    buffer_load_dwordx4 v16, s[44:47], s72 offen lds
    v_mfma_f32_32x32x16_bf16 v[208:223], v[180:183], v[184:187], v[208:223]
    v_mfma_f32_32x32x16_bf16 v[224:239], v[176:179], v[188:191], v[224:239]
    v_mfma_f32_32x32x16_bf16 v[240:255], v[180:183], v[188:191], v[240:255]
    s_waitcnt vmcnt(9)
    ds_read_b64_tr_b16 v[176:177], v32 offset:10240
    ds_read_b64_tr_b16 v[178:179], v32 offset:10752
    ds_read_b64_tr_b16 v[180:181], v33 offset:10240
    ds_read_b64_tr_b16 v[182:183], v33 offset:10752
    ds_read_b128 v[184:187], v21 offset:10240
    ds_read_b128 v[188:191], v21 offset:11264
    s_waitcnt lgkmcnt(6)
    v_mfma_f32_32x32x16_bf16 v[192:207], v[160:163], v[168:171], v[192:207]
    s_add_u32 m0, s69, 8192
    s_add_u32 s72, s70, 8192
    buffer_load_dwordx4 v16, s[44:47], s70 offen lds
    s_add_u32 m0, s69, 9216
    s_add_u32 s70, s70, 16384
    buffer_load_dwordx4 v16, s[44:47], s72 offen lds
    v_mfma_f32_32x32x16_bf16 v[208:223], v[164:167], v[168:171], v[208:223]
    v_mfma_f32_32x32x16_bf16 v[224:239], v[160:163], v[172:175], v[224:239]
    v_mfma_f32_32x32x16_bf16 v[240:255], v[164:167], v[172:175], v[240:255]
    s_waitcnt vmcnt(8)
    ds_read_b64_tr_b16 v[160:161], v32 offset:0
    ds_read_b64_tr_b16 v[162:163], v32 offset:512
    ds_read_b64_tr_b16 v[164:165], v33 offset:0
    ds_read_b64_tr_b16 v[166:167], v33 offset:512
    ds_read_b128 v[168:171], v21 offset:12288
    ds_read_b128 v[172:175], v21 offset:13312
    s_waitcnt lgkmcnt(6)
    v_mfma_f32_32x32x16_bf16 v[192:207], v[176:179], v[184:187], v[192:207]
    s_add_u32 m0, s69, 10240
    s_add_u32 s72, s70, 8192
    buffer_load_dwordx4 v16, s[44:47], s70 offen lds
    s_add_u32 m0, s69, 11264
    s_add_u32 s70, s70, 16384
    buffer_load_dwordx4 v16, s[44:47], s72 offen lds
    v_mfma_f32_32x32x16_bf16 v[208:223], v[180:183], v[184:187], v[208:223]
    v_mfma_f32_32x32x16_bf16 v[224:239], v[176:179], v[188:191], v[224:239]
    v_mfma_f32_32x32x16_bf16 v[240:255], v[180:183], v[188:191], v[240:255]
    s_waitcnt vmcnt(8)
    ds_read_b64_tr_b16 v[176:177], v32 offset:2048
    ds_read_b64_tr_b16 v[178:179], v32 offset:2560
    ds_read_b64_tr_b16 v[180:181], v33 offset:2048
    ds_read_b64_tr_b16 v[182:183], v33 offset:2560
    ds_read_b128 v[184:187], v21 offset:14336
    ds_read_b128 v[188:191], v21 offset:15360
    s_waitcnt lgkmcnt(6)
    v_mfma_f32_32x32x16_bf16 v[192:207], v[160:163], v[168:171], v[192:207]
    s_add_u32 m0, s69, 0
    s_add_u32 s72, s70, 8192
    buffer_load_dwordx4 v16, s[44:47], s70 offen lds
    s_add_u32 m0, s69, 1024
    s_add_u32 s70, s70, 16384
    buffer_load_dwordx4 v16, s[44:47], s72 offen lds
    v_mfma_f32_32x32x16_bf16 v[208:223], v[164:167], v[168:171], v[208:223]
    v_mfma_f32_32x32x16_bf16 v[224:239], v[160:163], v[172:175], v[224:239]
    v_mfma_f32_32x32x16_bf16 v[240:255], v[164:167], v[172:175], v[240:255]
    s_waitcnt vmcnt(8)
    ds_read_b64_tr_b16 v[160:161], v32 offset:4096
    ds_read_b64_tr_b16 v[162:163], v32 offset:4608
    ds_read_b64_tr_b16 v[164:165], v33 offset:4096
    ds_read_b64_tr_b16 v[166:167], v33 offset:4608
    ds_read_b128 v[168:171], v21 offset:16384
    ds_read_b128 v[172:175], v21 offset:17408
    s_waitcnt lgkmcnt(6)
    v_mfma_f32_32x32x16_bf16 v[192:207], v[176:179], v[184:187], v[192:207]
    s_add_u32 m0, s69, 2048
    s_add_u32 s72, s70, 8192
    buffer_load_dwordx4 v16, s[44:47], s70 offen lds
    s_add_u32 m0, s69, 3072
    s_add_u32 s70, s70, 16384
    buffer_load_dwordx4 v16, s[44:47], s72 offen lds
    v_mfma_f32_32x32x16_bf16 v[208:223], v[180:183], v[184:187], v[208:223]
    v_mfma_f32_32x32x16_bf16 v[224:239], v[176:179], v[188:191], v[224:239]
    v_mfma_f32_32x32x16_bf16 v[240:255], v[180:183], v[188:191], v[240:255]
    v_readlane_b32 s72, v29, 1
    v_readlane_b32 s34, v29, 0
    s_lshr_b32 s73, s72, 4
    s_and_b32 s73, s73, 0x0f0f0f0f
    s_and_b32 s76, s72, 0x0f0f0f0f
    s_add_u32 s73, s73, s76
    s_mul_i32 s73, s73, 0x01010101
    s_lshr_b32 s73, s73, 24
    s_lshl_b32 s73, s73, 8
    s_add_u32 s73, s73, s34
    s_cmp_eq_u32 s73, 2112
    s_cbranch_scc1 K_ckok
    s_mov_b32 s71, 40000
adaLN_cond__sliding_block_cached__dense_activation_squared_relu__prompt_kernel_ck8:
    buffer_load_dword v29, v31, s[56:59], 0 offen sc1
    s_waitcnt vmcnt(0)
    v_readlane_b32 s72, v29, 1
    v_readlane_b32 s34, v29, 0
    s_lshr_b32 s73, s72, 4
    s_and_b32 s73, s73, 0x0f0f0f0f
    s_and_b32 s76, s72, 0x0f0f0f0f
    s_add_u32 s73, s73, s76
    s_mul_i32 s73, s73, 0x01010101
    s_lshr_b32 s73, s73, 24
    s_lshl_b32 s73, s73, 8
    s_add_u32 s73, s73, s34
    s_cmp_eq_u32 s73, 2112
    s_cbranch_scc1 adaLN_cond__sliding_block_cached__dense_activation_squared_relu__prompt_kernel_ckd9
    s_sleep 1
    s_sub_u32 s71, s71, 1
    s_cmp_lg_u32 s71, 0
    s_cbranch_scc1 adaLN_cond__sliding_block_cached__dense_activation_squared_relu__prompt_kernel_ck8
adaLN_cond__sliding_block_cached__dense_activation_squared_relu__prompt_kernel_ckd9:
K_ckok:
    s_lshr_b32 s72, s72, s74
    s_and_b32 s72, s72, 15
    s_cmp_eq_u32 s72, 8
    s_cselect_b32 s34, 1, 0
    s_mov_b32 s48, s4
    s_mov_b32 s49, s5
    s_mov_b32 s50, 2097152
    s_mov_b32 s51, 0x00020000
    buffer_load_dwordx4 v[128:131], v41, s[48:51], 0 offen
    buffer_load_dwordx4 v[132:135], v42, s[60:63], 0 offen offset:2048 sc1
    buffer_load_dwordx4 v[136:139], v42, s[60:63], 0 offen offset:3072 sc1
    s_mov_b32 s71, 4096
    buffer_load_dwordx4 v[140:143], v42, s[60:63], s71 offen sc1
    s_lshl_b32 s71, s66, 7
    s_and_b32 s72, s64, 3
    s_lshl_b32 s72, s72, 5
    s_add_u32 s71, s71, s72
    v_lshrrev_b32 v22, 5, v0
    v_lshlrev_b32 v22, 4, v22
    v_add_u32 v43, s71, v22
    s_mov_b32 s71, 5120
    buffer_load_dwordx4 v[144:147], v43, s[60:63], s71 offen sc1
    s_mov_b32 s48, s22
    s_mov_b32 s49, s23
    s_mov_b32 s50, 1024
    s_mov_b32 s51, 0x00020000
    buffer_load_dwordx4 v[148:151], v43, s[48:51], 0 offen
    s_mov_b32 s48, s18
    s_mov_b32 s49, s19
    s_mov_b32 s50, 3584
    s_mov_b32 s51, 0x00020000
    s_mul_i32 s78, s66, 448
    s_lshl_b32 s71, s64, 6
    s_add_u32 s78, s78, s71
    v_lshrrev_b32 v22, 5, v0
    v_lshlrev_b32 v22, 4, v22
    buffer_load_dwordx4 v[152:155], v22, s[48:51], s78 offen
    buffer_load_dwordx4 v[156:159], v22, s[48:51], s78 offen offset:32
    s_waitcnt vmcnt(16)
    ds_read_b64_tr_b16 v[176:177], v32 offset:6144
    ds_read_b64_tr_b16 v[178:179], v32 offset:6656
    ds_read_b64_tr_b16 v[180:181], v33 offset:6144
    ds_read_b64_tr_b16 v[182:183], v33 offset:6656
    ds_read_b128 v[184:187], v21 offset:18432
    ds_read_b128 v[188:191], v21 offset:19456
    s_waitcnt lgkmcnt(6)
    v_mfma_f32_32x32x16_bf16 v[192:207], v[160:163], v[168:171], v[192:207]
    s_add_u32 m0, s69, 4096
    s_add_u32 s72, s70, 8192
    buffer_load_dwordx4 v16, s[44:47], s70 offen lds
    s_add_u32 m0, s69, 5120
    s_add_u32 s70, s70, 16384
    buffer_load_dwordx4 v16, s[44:47], s72 offen lds
    v_mfma_f32_32x32x16_bf16 v[208:223], v[164:167], v[168:171], v[208:223]
    v_mfma_f32_32x32x16_bf16 v[224:239], v[160:163], v[172:175], v[224:239]
    v_mfma_f32_32x32x16_bf16 v[240:255], v[164:167], v[172:175], v[240:255]
    s_waitcnt vmcnt(16)
    ds_read_b64_tr_b16 v[160:161], v32 offset:8192
    ds_read_b64_tr_b16 v[162:163], v32 offset:8704
    ds_read_b64_tr_b16 v[164:165], v33 offset:8192
    ds_read_b64_tr_b16 v[166:167], v33 offset:8704
    ds_read_b128 v[168:171], v21 offset:20480
    ds_read_b128 v[172:175], v21 offset:21504
    s_waitcnt lgkmcnt(6)
    v_mfma_f32_32x32x16_bf16 v[192:207], v[176:179], v[184:187], v[192:207]
    s_add_u32 m0, s69, 6144
    s_add_u32 s72, s70, 8192
    buffer_load_dwordx4 v16, s[44:47], s70 offen lds
    s_add_u32 m0, s69, 7168
    s_add_u32 s70, s70, 16384
    buffer_load_dwordx4 v16, s[44:47], s72 offen lds
    v_mfma_f32_32x32x16_bf16 v[208:223], v[180:183], v[184:187], v[208:223]
    v_mfma_f32_32x32x16_bf16 v[224:239], v[176:179], v[188:191], v[224:239]
    v_mfma_f32_32x32x16_bf16 v[240:255], v[180:183], v[188:191], v[240:255]
    s_waitcnt vmcnt(16)
    ds_read_b64_tr_b16 v[176:177], v32 offset:10240
    ds_read_b64_tr_b16 v[178:179], v32 offset:10752
    ds_read_b64_tr_b16 v[180:181], v33 offset:10240
    ds_read_b64_tr_b16 v[182:183], v33 offset:10752
    ds_read_b128 v[184:187], v21 offset:22528
    ds_read_b128 v[188:191], v21 offset:23552
    s_waitcnt lgkmcnt(6)
    v_mfma_f32_32x32x16_bf16 v[192:207], v[160:163], v[168:171], v[192:207]
    s_add_u32 m0, s69, 8192
    s_add_u32 s72, s70, 8192
    buffer_load_dwordx4 v16, s[44:47], s70 offen lds
    s_add_u32 m0, s69, 9216
    s_add_u32 s70, s70, 16384
    buffer_load_dwordx4 v16, s[44:47], s72 offen lds
    v_mfma_f32_32x32x16_bf16 v[208:223], v[164:167], v[168:171], v[208:223]
    v_mfma_f32_32x32x16_bf16 v[224:239], v[160:163], v[172:175], v[224:239]
    v_mfma_f32_32x32x16_bf16 v[240:255], v[164:167], v[172:175], v[240:255]
    s_waitcnt vmcnt(16)
    ds_read_b64_tr_b16 v[160:161], v32 offset:0
    ds_read_b64_tr_b16 v[162:163], v32 offset:512
    ds_read_b64_tr_b16 v[164:165], v33 offset:0
    ds_read_b64_tr_b16 v[166:167], v33 offset:512
    ds_read_b128 v[168:171], v21 offset:24576
    ds_read_b128 v[172:175], v21 offset:25600
    s_waitcnt lgkmcnt(6)
    v_mfma_f32_32x32x16_bf16 v[192:207], v[176:179], v[184:187], v[192:207]
    s_add_u32 m0, s69, 10240
    s_add_u32 s72, s70, 8192
    buffer_load_dwordx4 v16, s[44:47], s70 offen lds
    s_add_u32 m0, s69, 11264
    s_add_u32 s70, s70, 16384
    buffer_load_dwordx4 v16, s[44:47], s72 offen lds
    v_mfma_f32_32x32x16_bf16 v[208:223], v[180:183], v[184:187], v[208:223]
    v_mfma_f32_32x32x16_bf16 v[224:239], v[176:179], v[188:191], v[224:239]
    v_mfma_f32_32x32x16_bf16 v[240:255], v[180:183], v[188:191], v[240:255]
    s_waitcnt vmcnt(16)
    ds_read_b64_tr_b16 v[176:177], v32 offset:2048
    ds_read_b64_tr_b16 v[178:179], v32 offset:2560
    ds_read_b64_tr_b16 v[180:181], v33 offset:2048
    ds_read_b64_tr_b16 v[182:183], v33 offset:2560
    ds_read_b128 v[184:187], v21 offset:26624
    ds_read_b128 v[188:191], v21 offset:27648
    s_waitcnt lgkmcnt(6)
    v_mfma_f32_32x32x16_bf16 v[192:207], v[160:163], v[168:171], v[192:207]
    s_add_u32 m0, s69, 0
    s_add_u32 s72, s70, 8192
    buffer_load_dwordx4 v16, s[44:47], s70 offen lds
    s_add_u32 m0, s69, 1024
    s_add_u32 s70, s70, 16384
    buffer_load_dwordx4 v16, s[44:47], s72 offen lds
    v_mfma_f32_32x32x16_bf16 v[208:223], v[164:167], v[168:171], v[208:223]
    v_mfma_f32_32x32x16_bf16 v[224:239], v[160:163], v[172:175], v[224:239]
    v_mfma_f32_32x32x16_bf16 v[240:255], v[164:167], v[172:175], v[240:255]
    s_waitcnt vmcnt(8)
    ds_read_b64_tr_b16 v[160:161], v32 offset:4096
    ds_read_b64_tr_b16 v[162:163], v32 offset:4608
    ds_read_b64_tr_b16 v[164:165], v33 offset:4096
    ds_read_b64_tr_b16 v[166:167], v33 offset:4608
    ds_read_b128 v[168:171], v21 offset:28672
    ds_read_b128 v[172:175], v21 offset:29696
    s_waitcnt lgkmcnt(6)
    v_mfma_f32_32x32x16_bf16 v[192:207], v[176:179], v[184:187], v[192:207]
    s_add_u32 m0, s69, 2048
    s_add_u32 s72, s70, 8192
    buffer_load_dwordx4 v16, s[44:47], s70 offen lds
    s_add_u32 m0, s69, 3072
    s_add_u32 s70, s70, 16384
    buffer_load_dwordx4 v16, s[44:47], s72 offen lds
    v_mfma_f32_32x32x16_bf16 v[208:223], v[180:183], v[184:187], v[208:223]
    v_mfma_f32_32x32x16_bf16 v[224:239], v[176:179], v[188:191], v[224:239]
    v_mfma_f32_32x32x16_bf16 v[240:255], v[180:183], v[188:191], v[240:255]
    s_waitcnt vmcnt(8)
    ds_read_b64_tr_b16 v[176:177], v32 offset:6144
    ds_read_b64_tr_b16 v[178:179], v32 offset:6656
    ds_read_b64_tr_b16 v[180:181], v33 offset:6144
    ds_read_b64_tr_b16 v[182:183], v33 offset:6656
    ds_read_b128 v[184:187], v21 offset:30720
    ds_read_b128 v[188:191], v21 offset:31744
    s_waitcnt lgkmcnt(6)
    v_mfma_f32_32x32x16_bf16 v[192:207], v[160:163], v[168:171], v[192:207]
    s_add_u32 m0, s69, 4096
    s_add_u32 s72, s70, 8192
    buffer_load_dwordx4 v16, s[44:47], s70 offen lds
    s_add_u32 m0, s69, 5120
    s_add_u32 s70, s70, 16384
    buffer_load_dwordx4 v16, s[44:47], s72 offen lds
    v_mfma_f32_32x32x16_bf16 v[208:223], v[164:167], v[168:171], v[208:223]
    v_mfma_f32_32x32x16_bf16 v[224:239], v[160:163], v[172:175], v[224:239]
    v_mfma_f32_32x32x16_bf16 v[240:255], v[164:167], v[172:175], v[240:255]
    s_waitcnt vmcnt(8)
    ds_read_b64_tr_b16 v[160:161], v32 offset:8192
    ds_read_b64_tr_b16 v[162:163], v32 offset:8704
    ds_read_b64_tr_b16 v[164:165], v33 offset:8192
    ds_read_b64_tr_b16 v[166:167], v33 offset:8704
    ds_read_b128 v[168:171], v21 offset:32768
    ds_read_b128 v[172:175], v21 offset:33792
    s_waitcnt lgkmcnt(6)
    v_mfma_f32_32x32x16_bf16 v[192:207], v[176:179], v[184:187], v[192:207]
    s_add_u32 m0, s69, 6144
    s_add_u32 s72, s70, 8192
    buffer_load_dwordx4 v16, s[44:47], s70 offen lds
    s_add_u32 m0, s69, 7168
    s_add_u32 s70, s70, 16384
    buffer_load_dwordx4 v16, s[44:47], s72 offen lds
    v_mfma_f32_32x32x16_bf16 v[208:223], v[180:183], v[184:187], v[208:223]
    v_mfma_f32_32x32x16_bf16 v[224:239], v[176:179], v[188:191], v[224:239]
    v_mfma_f32_32x32x16_bf16 v[240:255], v[180:183], v[188:191], v[240:255]
    s_waitcnt vmcnt(8)
    ds_read_b64_tr_b16 v[176:177], v32 offset:10240
    ds_read_b64_tr_b16 v[178:179], v32 offset:10752
    ds_read_b64_tr_b16 v[180:181], v33 offset:10240
    ds_read_b64_tr_b16 v[182:183], v33 offset:10752
    ds_read_b128 v[184:187], v21 offset:34816
    ds_read_b128 v[188:191], v21 offset:35840
    s_waitcnt lgkmcnt(6)
    v_mfma_f32_32x32x16_bf16 v[192:207], v[160:163], v[168:171], v[192:207]
    s_add_u32 m0, s69, 8192
    s_add_u32 s72, s70, 8192
    buffer_load_dwordx4 v16, s[44:47], s70 offen lds
    s_add_u32 m0, s69, 9216
    s_add_u32 s70, s70, 16384
    buffer_load_dwordx4 v16, s[44:47], s72 offen lds
    v_mfma_f32_32x32x16_bf16 v[208:223], v[164:167], v[168:171], v[208:223]
    v_mfma_f32_32x32x16_bf16 v[224:239], v[160:163], v[172:175], v[224:239]
    v_mfma_f32_32x32x16_bf16 v[240:255], v[164:167], v[172:175], v[240:255]
    s_waitcnt vmcnt(8)
    ds_read_b64_tr_b16 v[160:161], v32 offset:0
    ds_read_b64_tr_b16 v[162:163], v32 offset:512
    ds_read_b64_tr_b16 v[164:165], v33 offset:0
    ds_read_b64_tr_b16 v[166:167], v33 offset:512
    ds_read_b128 v[168:171], v21 offset:36864
    ds_read_b128 v[172:175], v21 offset:37888
    s_waitcnt lgkmcnt(6)
    v_mfma_f32_32x32x16_bf16 v[192:207], v[176:179], v[184:187], v[192:207]
    s_add_u32 m0, s69, 10240
    s_add_u32 s72, s70, 8192
    buffer_load_dwordx4 v16, s[44:47], s70 offen lds
    s_add_u32 m0, s69, 11264
    s_add_u32 s70, s70, 16384
    buffer_load_dwordx4 v16, s[44:47], s72 offen lds
    v_mfma_f32_32x32x16_bf16 v[208:223], v[180:183], v[184:187], v[208:223]
    v_mfma_f32_32x32x16_bf16 v[224:239], v[176:179], v[188:191], v[224:239]
    v_mfma_f32_32x32x16_bf16 v[240:255], v[180:183], v[188:191], v[240:255]
    s_waitcnt vmcnt(8)
    ds_read_b64_tr_b16 v[176:177], v32 offset:2048
    ds_read_b64_tr_b16 v[178:179], v32 offset:2560
    ds_read_b64_tr_b16 v[180:181], v33 offset:2048
    ds_read_b64_tr_b16 v[182:183], v33 offset:2560
    ds_read_b128 v[184:187], v21 offset:38912
    ds_read_b128 v[188:191], v21 offset:39936
    s_waitcnt lgkmcnt(6)
    v_mfma_f32_32x32x16_bf16 v[192:207], v[160:163], v[168:171], v[192:207]
    s_add_u32 m0, s69, 0
    s_add_u32 s72, s70, 8192
    buffer_load_dwordx4 v16, s[44:47], s70 offen lds
    s_add_u32 m0, s69, 1024
    s_add_u32 s70, s70, 16384
    buffer_load_dwordx4 v16, s[44:47], s72 offen lds
    v_mfma_f32_32x32x16_bf16 v[208:223], v[164:167], v[168:171], v[208:223]
    v_mfma_f32_32x32x16_bf16 v[224:239], v[160:163], v[172:175], v[224:239]
    v_mfma_f32_32x32x16_bf16 v[240:255], v[164:167], v[172:175], v[240:255]
    s_waitcnt vmcnt(8)
    ds_read_b64_tr_b16 v[160:161], v32 offset:4096
    ds_read_b64_tr_b16 v[162:163], v32 offset:4608
    ds_read_b64_tr_b16 v[164:165], v33 offset:4096
    ds_read_b64_tr_b16 v[166:167], v33 offset:4608
    ds_read_b128 v[168:171], v21 offset:40960
    ds_read_b128 v[172:175], v21 offset:41984
    s_waitcnt lgkmcnt(6)
    v_mfma_f32_32x32x16_bf16 v[192:207], v[176:179], v[184:187], v[192:207]
    s_add_u32 m0, s69, 2048
    s_add_u32 s72, s70, 8192
    buffer_load_dwordx4 v16, s[44:47], s70 offen lds
    s_add_u32 m0, s69, 3072
    s_add_u32 s70, s70, 16384
    buffer_load_dwordx4 v16, s[44:47], s72 offen lds
    v_mfma_f32_32x32x16_bf16 v[208:223], v[180:183], v[184:187], v[208:223]
    v_mfma_f32_32x32x16_bf16 v[224:239], v[176:179], v[188:191], v[224:239]
    v_mfma_f32_32x32x16_bf16 v[240:255], v[180:183], v[188:191], v[240:255]
    s_waitcnt vmcnt(8)
    ds_read_b64_tr_b16 v[176:177], v32 offset:6144
    ds_read_b64_tr_b16 v[178:179], v32 offset:6656
    ds_read_b64_tr_b16 v[180:181], v33 offset:6144
    ds_read_b64_tr_b16 v[182:183], v33 offset:6656
    ds_read_b128 v[184:187], v21 offset:43008
    ds_read_b128 v[188:191], v21 offset:44032
    s_waitcnt lgkmcnt(6)
    v_mfma_f32_32x32x16_bf16 v[192:207], v[160:163], v[168:171], v[192:207]
    s_add_u32 m0, s69, 4096
    s_add_u32 s72, s70, 8192
    buffer_load_dwordx4 v16, s[44:47], s70 offen lds
    s_add_u32 m0, s69, 5120
    s_add_u32 s70, s70, 16384
    buffer_load_dwordx4 v16, s[44:47], s72 offen lds
    v_mfma_f32_32x32x16_bf16 v[208:223], v[164:167], v[168:171], v[208:223]
    v_mfma_f32_32x32x16_bf16 v[224:239], v[160:163], v[172:175], v[224:239]
    v_mfma_f32_32x32x16_bf16 v[240:255], v[164:167], v[172:175], v[240:255]
    s_waitcnt vmcnt(8)
    ds_read_b64_tr_b16 v[160:161], v32 offset:8192
    ds_read_b64_tr_b16 v[162:163], v32 offset:8704
    ds_read_b64_tr_b16 v[164:165], v33 offset:8192
    ds_read_b64_tr_b16 v[166:167], v33 offset:8704
    ds_read_b128 v[168:171], v21 offset:45056
    ds_read_b128 v[172:175], v21 offset:46080
    s_waitcnt lgkmcnt(6)
    v_mfma_f32_32x32x16_bf16 v[192:207], v[176:179], v[184:187], v[192:207]
    s_add_u32 m0, s69, 6144
    s_add_u32 s72, s70, 8192
    buffer_load_dwordx4 v16, s[44:47], s70 offen lds
    s_add_u32 m0, s69, 7168
    s_add_u32 s70, s70, 16384
    buffer_load_dwordx4 v16, s[44:47], s72 offen lds
    v_mfma_f32_32x32x16_bf16 v[208:223], v[180:183], v[184:187], v[208:223]
    v_mfma_f32_32x32x16_bf16 v[224:239], v[176:179], v[188:191], v[224:239]
    v_mfma_f32_32x32x16_bf16 v[240:255], v[180:183], v[188:191], v[240:255]
    s_waitcnt vmcnt(8)
    ds_read_b64_tr_b16 v[176:177], v32 offset:10240
    ds_read_b64_tr_b16 v[178:179], v32 offset:10752
    ds_read_b64_tr_b16 v[180:181], v33 offset:10240
    ds_read_b64_tr_b16 v[182:183], v33 offset:10752
    ds_read_b128 v[184:187], v21 offset:47104
    ds_read_b128 v[188:191], v21 offset:48128
    s_waitcnt lgkmcnt(6)
    v_mfma_f32_32x32x16_bf16 v[192:207], v[160:163], v[168:171], v[192:207]
    s_add_u32 m0, s69, 8192
    s_add_u32 s72, s70, 8192
    buffer_load_dwordx4 v16, s[44:47], s70 offen lds
    s_add_u32 m0, s69, 9216
    s_add_u32 s70, s70, 16384
    buffer_load_dwordx4 v16, s[44:47], s72 offen lds
    v_mfma_f32_32x32x16_bf16 v[208:223], v[164:167], v[168:171], v[208:223]
    v_mfma_f32_32x32x16_bf16 v[224:239], v[160:163], v[172:175], v[224:239]
    v_mfma_f32_32x32x16_bf16 v[240:255], v[164:167], v[172:175], v[240:255]
    s_waitcnt vmcnt(8)
    ds_read_b64_tr_b16 v[160:161], v32 offset:0
    ds_read_b64_tr_b16 v[162:163], v32 offset:512
    ds_read_b64_tr_b16 v[164:165], v33 offset:0
    ds_read_b64_tr_b16 v[166:167], v33 offset:512
    ds_read_b128 v[168:171], v21 offset:49152
    ds_read_b128 v[172:175], v21 offset:50176
    s_waitcnt lgkmcnt(6)
    v_mfma_f32_32x32x16_bf16 v[192:207], v[176:179], v[184:187], v[192:207]
    s_add_u32 m0, s69, 10240
    s_add_u32 s72, s70, 8192
    buffer_load_dwordx4 v16, s[44:47], s70 offen lds
    s_add_u32 m0, s69, 11264
    s_add_u32 s70, s70, 16384
    buffer_load_dwordx4 v16, s[44:47], s72 offen lds
    v_mfma_f32_32x32x16_bf16 v[208:223], v[180:183], v[184:187], v[208:223]
    v_mfma_f32_32x32x16_bf16 v[224:239], v[176:179], v[188:191], v[224:239]
    v_mfma_f32_32x32x16_bf16 v[240:255], v[180:183], v[188:191], v[240:255]
    s_waitcnt vmcnt(8)
    ds_read_b64_tr_b16 v[176:177], v32 offset:2048
    ds_read_b64_tr_b16 v[178:179], v32 offset:2560
    ds_read_b64_tr_b16 v[180:181], v33 offset:2048
    ds_read_b64_tr_b16 v[182:183], v33 offset:2560
    ds_read_b128 v[184:187], v21 offset:51200
    ds_read_b128 v[188:191], v21 offset:52224
    s_waitcnt lgkmcnt(6)
    v_mfma_f32_32x32x16_bf16 v[192:207], v[160:163], v[168:171], v[192:207]
    s_add_u32 m0, s69, 0
    s_add_u32 s72, s70, 8192
    buffer_load_dwordx4 v16, s[44:47], s70 offen lds
    s_add_u32 m0, s69, 1024
    s_add_u32 s70, s70, 16384
    buffer_load_dwordx4 v16, s[44:47], s72 offen lds
    v_mfma_f32_32x32x16_bf16 v[208:223], v[164:167], v[168:171], v[208:223]
    v_mfma_f32_32x32x16_bf16 v[224:239], v[160:163], v[172:175], v[224:239]
    v_mfma_f32_32x32x16_bf16 v[240:255], v[164:167], v[172:175], v[240:255]
    s_waitcnt vmcnt(8)
    ds_read_b64_tr_b16 v[160:161], v32 offset:4096
    ds_read_b64_tr_b16 v[162:163], v32 offset:4608
    ds_read_b64_tr_b16 v[164:165], v33 offset:4096
    ds_read_b64_tr_b16 v[166:167], v33 offset:4608
    ds_read_b128 v[168:171], v21 offset:53248
    ds_read_b128 v[172:175], v21 offset:54272
    s_waitcnt lgkmcnt(6)
    v_mfma_f32_32x32x16_bf16 v[192:207], v[176:179], v[184:187], v[192:207]
    s_add_u32 m0, s69, 2048
    s_add_u32 s72, s70, 8192
    buffer_load_dwordx4 v16, s[44:47], s70 offen lds
    s_add_u32 m0, s69, 3072
    s_add_u32 s70, s70, 16384
    buffer_load_dwordx4 v16, s[44:47], s72 offen lds
    v_mfma_f32_32x32x16_bf16 v[208:223], v[180:183], v[184:187], v[208:223]
    v_mfma_f32_32x32x16_bf16 v[224:239], v[176:179], v[188:191], v[224:239]
    v_mfma_f32_32x32x16_bf16 v[240:255], v[180:183], v[188:191], v[240:255]
    s_barrier
    s_add_u32 m0, s80, 0
    s_add_u32 s72, s84, 8192
    buffer_load_dwordx4 v16, s[36:39], s84 offen lds
    s_add_u32 m0, s80, 1024
    s_add_u32 s84, s84, 16384
    buffer_load_dwordx4 v16, s[36:39], s72 offen lds
    s_add_u32 m0, s80, 2048
    s_add_u32 s72, s84, 8192
    buffer_load_dwordx4 v16, s[36:39], s84 offen lds
    s_add_u32 m0, s80, 3072
    s_add_u32 s84, s84, 16384
    buffer_load_dwordx4 v16, s[36:39], s72 offen lds
    v_lshlrev_b32 v26, 7, v0
    buffer_load_dword v30, v26, s[52:55], s83 offen sc1
    s_waitcnt vmcnt(13)
    ds_read_b64_tr_b16 v[176:177], v32 offset:6144
    ds_read_b64_tr_b16 v[178:179], v32 offset:6656
    ds_read_b64_tr_b16 v[180:181], v33 offset:6144
    ds_read_b64_tr_b16 v[182:183], v33 offset:6656
    ds_read_b128 v[184:187], v21 offset:55296
    ds_read_b128 v[188:191], v21 offset:56320
    s_waitcnt lgkmcnt(6)
    v_mfma_f32_32x32x16_bf16 v[192:207], v[160:163], v[168:171], v[192:207]
    v_mfma_f32_32x32x16_bf16 v[208:223], v[164:167], v[168:171], v[208:223]
    v_mfma_f32_32x32x16_bf16 v[224:239], v[160:163], v[172:175], v[224:239]
    v_mfma_f32_32x32x16_bf16 v[240:255], v[164:167], v[172:175], v[240:255]
    s_add_u32 m0, s69, 4096
    s_add_u32 s72, s84, 8192
    buffer_load_dwordx4 v16, s[36:39], s84 offen lds
    s_add_u32 m0, s69, 5120
    s_add_u32 s84, s84, 16384
    buffer_load_dwordx4 v16, s[36:39], s72 offen lds
    s_waitcnt vmcnt(13)
    ds_read_b64_tr_b16 v[160:161], v32 offset:8192
    ds_read_b64_tr_b16 v[162:163], v32 offset:8704
    ds_read_b64_tr_b16 v[164:165], v33 offset:8192
    ds_read_b64_tr_b16 v[166:167], v33 offset:8704
    ds_read_b128 v[168:171], v21 offset:57344
    ds_read_b128 v[172:175], v21 offset:58368
    s_waitcnt lgkmcnt(6)
    v_mfma_f32_32x32x16_bf16 v[192:207], v[176:179], v[184:187], v[192:207]
    v_mfma_f32_32x32x16_bf16 v[208:223], v[180:183], v[184:187], v[208:223]
    v_mfma_f32_32x32x16_bf16 v[224:239], v[176:179], v[188:191], v[224:239]
    v_mfma_f32_32x32x16_bf16 v[240:255], v[180:183], v[188:191], v[240:255]
    s_add_u32 m0, s69, 6144
    s_add_u32 s72, s84, 8192
    buffer_load_dwordx4 v16, s[36:39], s84 offen lds
    s_add_u32 m0, s69, 7168
    s_add_u32 s84, s84, 16384
    buffer_load_dwordx4 v16, s[36:39], s72 offen lds
    s_waitcnt vmcnt(13)
    ds_read_b64_tr_b16 v[176:177], v32 offset:10240
    ds_read_b64_tr_b16 v[178:179], v32 offset:10752
    ds_read_b64_tr_b16 v[180:181], v33 offset:10240
    ds_read_b64_tr_b16 v[182:183], v33 offset:10752
    ds_read_b128 v[184:187], v21 offset:59392
    ds_read_b128 v[188:191], v21 offset:60416
    s_waitcnt lgkmcnt(6)
    v_mfma_f32_32x32x16_bf16 v[192:207], v[160:163], v[168:171], v[192:207]
    v_mfma_f32_32x32x16_bf16 v[208:223], v[164:167], v[168:171], v[208:223]
    v_mfma_f32_32x32x16_bf16 v[224:239], v[160:163], v[172:175], v[224:239]
    v_mfma_f32_32x32x16_bf16 v[240:255], v[164:167], v[172:175], v[240:255]
    s_add_u32 m0, s69, 8192
    s_add_u32 s72, s84, 8192
    buffer_load_dwordx4 v16, s[36:39], s84 offen lds
    s_add_u32 m0, s69, 9216
    s_add_u32 s84, s84, 16384
    buffer_load_dwordx4 v16, s[36:39], s72 offen lds
    s_waitcnt vmcnt(13)
    ds_read_b64_tr_b16 v[160:161], v32 offset:0
    ds_read_b64_tr_b16 v[162:163], v32 offset:512
    ds_read_b64_tr_b16 v[164:165], v33 offset:0
    ds_read_b64_tr_b16 v[166:167], v33 offset:512
    ds_read_b128 v[168:171], v21 offset:61440
    ds_read_b128 v[172:175], v21 offset:62464
    s_waitcnt lgkmcnt(6)
    v_mfma_f32_32x32x16_bf16 v[192:207], v[176:179], v[184:187], v[192:207]
    v_mfma_f32_32x32x16_bf16 v[208:223], v[180:183], v[184:187], v[208:223]
    v_mfma_f32_32x32x16_bf16 v[224:239], v[176:179], v[188:191], v[224:239]
    v_mfma_f32_32x32x16_bf16 v[240:255], v[180:183], v[188:191], v[240:255]
    s_add_u32 m0, s69, 10240
    s_add_u32 s72, s84, 8192
    buffer_load_dwordx4 v16, s[36:39], s84 offen lds
    s_add_u32 m0, s69, 11264
    s_add_u32 s84, s84, 16384
    buffer_load_dwordx4 v16, s[36:39], s72 offen lds
    s_waitcnt vmcnt(13)
    ds_read_b64_tr_b16 v[176:177], v32 offset:2048
    ds_read_b64_tr_b16 v[178:179], v32 offset:2560
    ds_read_b64_tr_b16 v[180:181], v33 offset:2048
    ds_read_b64_tr_b16 v[182:183], v33 offset:2560
    ds_read_b128 v[184:187], v21 offset:63488
    ds_read_b128 v[188:191], v21 offset:64512
    s_waitcnt lgkmcnt(6)
    v_mfma_f32_32x32x16_bf16 v[192:207], v[160:163], v[168:171], v[192:207]
    v_mfma_f32_32x32x16_bf16 v[208:223], v[164:167], v[168:171], v[208:223]
    v_mfma_f32_32x32x16_bf16 v[224:239], v[160:163], v[172:175], v[224:239]
    v_mfma_f32_32x32x16_bf16 v[240:255], v[164:167], v[172:175], v[240:255]
    s_add_u32 m0, s69, 0
    s_add_u32 s72, s84, 8192
    buffer_load_dwordx4 v16, s[36:39], s84 offen lds
    s_add_u32 m0, s69, 1024
    s_add_u32 s84, s84, 16384
    buffer_load_dwordx4 v16, s[36:39], s72 offen lds
    s_waitcnt lgkmcnt(0)
    v_mfma_f32_32x32x16_bf16 v[192:207], v[176:179], v[184:187], v[192:207]
    v_mfma_f32_32x32x16_bf16 v[208:223], v[180:183], v[184:187], v[208:223]
    v_mfma_f32_32x32x16_bf16 v[224:239], v[176:179], v[188:191], v[224:239]
    v_mfma_f32_32x32x16_bf16 v[240:255], v[180:183], v[188:191], v[240:255]
    s_add_u32 m0, s69, 2048
    s_add_u32 s72, s84, 8192
    buffer_load_dwordx4 v16, s[36:39], s84 offen lds
    s_add_u32 m0, s69, 3072
    s_add_u32 s84, s84, 16384
    buffer_load_dwordx4 v16, s[36:39], s72 offen lds
    s_lshl_b32 s71, s65, 3
    s_add_u32 s71, s71, s66
    s_lshl_b32 s71, s71, 16
    s_lshl_b32 s72, s64, 12
    s_add_u32 s77, s71, s72
    s_add_u32 s79, s77, 32768
    v_cvt_pk_bf16_f32 v96, v192, v193
    v_cvt_pk_bf16_f32 v97, v194, v195
    v_cvt_pk_bf16_f32 v98, v196, v197
    v_cvt_pk_bf16_f32 v99, v198, v199
    v_cvt_pk_bf16_f32 v100, v200, v201
    v_cvt_pk_bf16_f32 v101, v202, v203
    v_cvt_pk_bf16_f32 v102, v204, v205
    v_cvt_pk_bf16_f32 v103, v206, v207
    v_cvt_pk_bf16_f32 v104, v208, v209
    v_cvt_pk_bf16_f32 v105, v210, v211
    v_cvt_pk_bf16_f32 v106, v212, v213
    v_cvt_pk_bf16_f32 v107, v214, v215
    v_cvt_pk_bf16_f32 v108, v216, v217
    v_cvt_pk_bf16_f32 v109, v218, v219
    v_cvt_pk_bf16_f32 v110, v220, v221
    v_cvt_pk_bf16_f32 v111, v222, v223
    v_cvt_pk_bf16_f32 v112, v224, v225
    v_cvt_pk_bf16_f32 v113, v226, v227
    v_cvt_pk_bf16_f32 v114, v228, v229
    v_cvt_pk_bf16_f32 v115, v230, v231
    v_cvt_pk_bf16_f32 v116, v232, v233
    v_cvt_pk_bf16_f32 v117, v234, v235
    v_cvt_pk_bf16_f32 v118, v236, v237
    v_cvt_pk_bf16_f32 v119, v238, v239
    v_cvt_pk_bf16_f32 v120, v240, v241
    v_cvt_pk_bf16_f32 v121, v242, v243
    v_cvt_pk_bf16_f32 v122, v244, v245
    v_cvt_pk_bf16_f32 v123, v246, v247
    v_cvt_pk_bf16_f32 v124, v248, v249
    v_cvt_pk_bf16_f32 v125, v250, v251
    v_cvt_pk_bf16_f32 v126, v252, v253
    v_cvt_pk_bf16_f32 v127, v254, v255
    s_cmp_eq_u32 s34, 0
    s_cbranch_scc1 adaLN_cond__sliding_block_cached__dense_activation_squared_relu__prompt_kernel_du10
    buffer_store_dwordx4 v[96:99], v21, s[52:55], s77 offen offset:0
    buffer_store_dwordx4 v[100:103], v21, s[52:55], s77 offen offset:1024
    buffer_store_dwordx4 v[104:107], v21, s[52:55], s77 offen offset:2048
    buffer_store_dwordx4 v[108:111], v21, s[52:55], s77 offen offset:3072
    buffer_store_dwordx4 v[112:115], v21, s[52:55], s79 offen offset:0
    buffer_store_dwordx4 v[116:119], v21, s[52:55], s79 offen offset:1024
    buffer_store_dwordx4 v[120:123], v21, s[52:55], s79 offen offset:2048
    buffer_store_dwordx4 v[124:127], v21, s[52:55], s79 offen offset:3072
    s_branch adaLN_cond__sliding_block_cached__dense_activation_squared_relu__prompt_kernel_du11
adaLN_cond__sliding_block_cached__dense_activation_squared_relu__prompt_kernel_du10:
    buffer_store_dwordx4 v[96:99], v21, s[52:55], s77 offen offset:0 sc1
    buffer_store_dwordx4 v[100:103], v21, s[52:55], s77 offen offset:1024 sc1
    buffer_store_dwordx4 v[104:107], v21, s[52:55], s77 offen offset:2048 sc1
    buffer_store_dwordx4 v[108:111], v21, s[52:55], s77 offen offset:3072 sc1
    buffer_store_dwordx4 v[112:115], v21, s[52:55], s79 offen offset:0 sc1
    buffer_store_dwordx4 v[116:119], v21, s[52:55], s79 offen offset:1024 sc1
    buffer_store_dwordx4 v[120:123], v21, s[52:55], s79 offen offset:2048 sc1
    buffer_store_dwordx4 v[124:127], v21, s[52:55], s79 offen offset:3072 sc1
adaLN_cond__sliding_block_cached__dense_activation_squared_relu__prompt_kernel_du11:
    v_and_b32 v254, 7, v0
    v_lshlrev_b32 v254, 2, v254
    v_mov_b32 v255, 0
    v_mov_b32 v252, v40
    v_and_b32 v253, 31, v0
    s_lshl_b32 s71, s65, 6
    s_lshr_b32 s72, s64, 2
    s_lshl_b32 s72, s72, 5
    s_add_u32 s71, s71, s72
    v_add_u32 v253, s71, v253
    v_lshl_add_u32 v253, v253, 10, v43
    v_mov_b32 v5, v32
    v_mov_b32 v6, v33
    s_sub_u32 s71, s69, s80
    v_subrev_u32 v7, s71, v32
    v_subrev_u32 v8, s71, v33
    s_lshl_b32 s71, s64, 6
    v_add_u32 v10, s71, v0
    v_mul_u32_u24 v11, 2341, v10
    v_lshrrev_b32 v11, 16, v11
    v_mul_u32_u24 v12, 28, v11
    v_sub_u32 v10, v10, v12
    v_mul_u32_u24 v2, 3584, v11
    v_lshl_add_u32 v2, v10, 4, v2
    s_mul_i32 s70, s66, 448
    s_mul_i32 s82, s65, 458752
    s_lshl_b32 s85, s64, 10
    s_add_u32 s85, s85, 65536
    s_mov_b32 s44, s16
    s_mov_b32 s45, s17
    s_mov_b32 s46, 1835008
    s_mov_b32 s47, 0x00020000
    s_mov_b32 s40, s28
    s_mov_b32 s41, s29
    s_mov_b32 s42, 2097152
    s_mov_b32 s43, 0x00020000
    v_lshrrev_b32 v10, 5, v0
    v_bfe_u32 v11, v0, 2, 2
    v_bfe_u32 v12, v0, 4, 1
    v_lshlrev_b32 v12, 5, v12
    v_and_b32 v13, 1, v0
    v_lshl_add_u32 v12, v13, 4, v12
    v_bfe_u32 v13, v0, 1, 1
    v_lshl_add_u32 v12, v13, 3, v12
    v_lshl_add_u32 v13, v10, 3, v11
    v_mul_u32_u24 v3, 448, v13
    v_add_u32 v3, v3, v12
    s_lshl_b32 s71, s64, 6
    s_add_u32 s71, s71, 65536
    v_add_u32 v3, s71, v3
    v_add_u32 v4, 43008, v3
    s_waitcnt vmcnt(8)
    ds_read_b64_tr_b16 v[160:161], v7 offset:0
    ds_read_b64_tr_b16 v[162:163], v7 offset:512
    ds_read_b64_tr_b16 v[164:165], v8 offset:0
    ds_read_b64_tr_b16 v[166:167], v8 offset:512
    ds_read_b64_tr_b16 v[168:169], v7 offset:2048
    ds_read_b64_tr_b16 v[170:171], v7 offset:2560
    ds_read_b64_tr_b16 v[172:173], v8 offset:2048
    ds_read_b64_tr_b16 v[174:175], v8 offset:2560
    ds_read_b64_tr_b16 v[176:177], v5 offset:4096
    ds_read_b64_tr_b16 v[178:179], v5 offset:4608
    ds_read_b64_tr_b16 v[180:181], v6 offset:4096
    ds_read_b64_tr_b16 v[182:183], v6 offset:4608
    s_waitcnt lgkmcnt(2)
    ds_read_b64_tr_b16 v[184:185], v5 offset:6144
    ds_read_b64_tr_b16 v[186:187], v5 offset:6656
    ds_read_b64_tr_b16 v[188:189], v6 offset:6144
    ds_read_b64_tr_b16 v[190:191], v6 offset:6656
    ds_read_b64_tr_b16 v[192:193], v5 offset:8192
    ds_read_b64_tr_b16 v[194:195], v5 offset:8704
    ds_read_b64_tr_b16 v[196:197], v6 offset:8192
    ds_read_b64_tr_b16 v[198:199], v6 offset:8704
    ds_read_b64_tr_b16 v[200:201], v5 offset:10240
    ds_read_b64_tr_b16 v[202:203], v5 offset:10752
    ds_read_b64_tr_b16 v[204:205], v6 offset:10240
    ds_read_b64_tr_b16 v[206:207], v6 offset:10752
    s_waitcnt lgkmcnt(2)
    ds_read_b64_tr_b16 v[208:209], v5 offset:0
    ds_read_b64_tr_b16 v[210:211], v5 offset:512
    ds_read_b64_tr_b16 v[212:213], v6 offset:0
    ds_read_b64_tr_b16 v[214:215], v6 offset:512
    ds_read_b64_tr_b16 v[216:217], v5 offset:2048
    ds_read_b64_tr_b16 v[218:219], v5 offset:2560
    ds_read_b64_tr_b16 v[220:221], v6 offset:2048
    ds_read_b64_tr_b16 v[222:223], v6 offset:2560
    v_lshlrev_b32 v80, 16, v128
    v_and_b32 v81, s67, v128
    v_lshlrev_b32 v88, 16, v132
    v_and_b32 v89, s67, v132
    v_lshlrev_b32 v82, 16, v129
    v_and_b32 v83, s67, v129
    v_lshlrev_b32 v90, 16, v133
    v_and_b32 v91, s67, v133
    v_lshlrev_b32 v84, 16, v130
    v_and_b32 v85, s67, v130
    v_lshlrev_b32 v92, 16, v134
    v_and_b32 v93, s67, v134
    v_lshlrev_b32 v86, 16, v131
    v_and_b32 v87, s67, v131
    v_lshlrev_b32 v94, 16, v135
    v_and_b32 v95, s67, v135
    v_pk_mov_b32 v[244:245], v[144:145], v[144:145] op_sel:[0,1]
    v_pk_mov_b32 v[246:247], v[146:147], v[146:147] op_sel:[0,1]
    v_pk_mov_b32 v[248:249], v[148:149], v[148:149] op_sel:[0,1]
    v_pk_mov_b32 v[250:251], v[150:151], v[150:151] op_sel:[0,1]
    s_waitcnt lgkmcnt(0)
    s_lshl_b32 s73, s64, 5
    s_add_u32 s73, s73, s35
    s_lshl_b32 s71, s66, 2
    s_add_u32 s81, s71, s73
    v_mov_b32 v9, 1
    s_waitcnt vmcnt(0)
    s_cmp_eq_u32 s34, 0
    s_cbranch_scc1 adaLN_cond__sliding_block_cached__dense_activation_squared_relu__prompt_kernel_du12
    buffer_store_dword v9, v255, s[60:63], s81 offen offset:256
    s_branch adaLN_cond__sliding_block_cached__dense_activation_squared_relu__prompt_kernel_du13
adaLN_cond__sliding_block_cached__dense_activation_squared_relu__prompt_kernel_du12:
    buffer_store_dword v9, v255, s[60:63], s81 offen offset:256 sc1
adaLN_cond__sliding_block_cached__dense_activation_squared_relu__prompt_kernel_du13:
    s_add_u32 m0, s69, 4096
    s_add_u32 s72, s84, 8192
    buffer_load_dwordx4 v16, s[36:39], s84 offen lds
    s_add_u32 m0, s69, 5120
    s_add_u32 s84, s84, 16384
    buffer_load_dwordx4 v16, s[36:39], s72 offen lds
    s_add_u32 m0, s69, 6144
    s_add_u32 s72, s84, 8192
    buffer_load_dwordx4 v16, s[36:39], s84 offen lds
    s_add_u32 m0, s69, 7168
    s_add_u32 s84, s84, 16384
    buffer_load_dwordx4 v16, s[36:39], s72 offen lds
    s_add_u32 m0, s69, 8192
    s_add_u32 s72, s84, 8192
    buffer_load_dwordx4 v16, s[36:39], s84 offen lds
    s_add_u32 m0, s69, 9216
    s_add_u32 s84, s84, 16384
    buffer_load_dwordx4 v16, s[36:39], s72 offen lds
    s_add_u32 m0, s69, 10240
    s_add_u32 s72, s84, 8192
    buffer_load_dwordx4 v16, s[36:39], s84 offen lds
    s_add_u32 m0, s69, 11264
    s_add_u32 s84, s84, 16384
    buffer_load_dwordx4 v16, s[36:39], s72 offen lds
    s_add_u32 m0, s69, 0
    s_add_u32 s72, s84, 8192
    buffer_load_dwordx4 v16, s[36:39], s84 offen lds
    s_add_u32 m0, s69, 1024
    s_add_u32 s84, s84, 16384
    buffer_load_dwordx4 v16, s[36:39], s72 offen lds
    s_add_u32 m0, s69, 2048
    s_add_u32 s72, s84, 8192
    buffer_load_dwordx4 v16, s[36:39], s84 offen lds
    s_add_u32 m0, s69, 3072
    s_add_u32 s84, s84, 16384
    buffer_load_dwordx4 v16, s[36:39], s72 offen lds
    v_lshlrev_b32 v96, 16, v136
    v_and_b32 v97, s67, v136
    v_lshlrev_b32 v104, 16, v140
    v_and_b32 v105, s67, v140
    v_lshlrev_b32 v98, 16, v137
    v_and_b32 v99, s67, v137
    v_lshlrev_b32 v106, 16, v141
    v_and_b32 v107, s67, v141
    v_lshlrev_b32 v100, 16, v138
    v_and_b32 v101, s67, v138
    v_lshlrev_b32 v108, 16, v142
    v_and_b32 v109, s67, v142
    v_lshlrev_b32 v102, 16, v139
    v_and_b32 v103, s67, v139
    v_lshlrev_b32 v110, 16, v143
    v_and_b32 v111, s67, v143
    v_add_f32 v104, 1.0, v104
    v_add_f32 v105, 1.0, v105
    v_add_f32 v106, 1.0, v106
    v_add_f32 v107, 1.0, v107
    v_add_f32 v108, 1.0, v108
    v_add_f32 v109, 1.0, v109
    v_add_f32 v110, 1.0, v110
    v_add_f32 v111, 1.0, v111
    v_cvt_pk_bf16_f32 v24, v104, v105
    v_lshlrev_b32 v104, 16, v24
    v_and_b32 v105, s67, v24
    v_cvt_pk_bf16_f32 v24, v106, v107
    v_lshlrev_b32 v106, 16, v24
    v_and_b32 v107, s67, v24
    v_cvt_pk_bf16_f32 v24, v108, v109
    v_lshlrev_b32 v108, 16, v24
    v_and_b32 v109, s67, v24
    v_cvt_pk_bf16_f32 v24, v110, v111
    v_lshlrev_b32 v110, 16, v24
    v_and_b32 v111, s67, v24
    v_lshlrev_b32 v112, 16, v152
    v_and_b32 v113, s67, v152
    v_lshlrev_b32 v114, 16, v153
    v_and_b32 v115, s67, v153
    v_lshlrev_b32 v116, 16, v154
    v_and_b32 v117, s67, v154
    v_lshlrev_b32 v118, 16, v155
    v_and_b32 v119, s67, v155
    v_lshlrev_b32 v120, 16, v156
    v_and_b32 v121, s67, v156
    v_lshlrev_b32 v122, 16, v157
    v_and_b32 v123, s67, v157
    v_lshlrev_b32 v124, 16, v158
    v_and_b32 v125, s67, v158
    v_lshlrev_b32 v126, 16, v159
    v_and_b32 v127, s67, v159
    s_lshl_b32 s71, s64, 3
    v_and_b32 v13, 7, v0
    v_lshlrev_b32 v13, 6, v13
    v_add_u32 v13, 52736, v13
    v_add_u32 v12, s71, v13
    s_mov_b32 s71, 40000
adaLN_cond__sliding_block_cached__dense_activation_squared_relu__prompt_kernel_pl14:
    buffer_load_dword v9, v254, s[60:63], s73 offen offset:256 sc1
    s_waitcnt vmcnt(0)
    v_cmp_ne_u32 vcc, 0, v9
    s_nop 0
    s_cmp_eq_u64 vcc, -1
    s_cbranch_scc1 adaLN_cond__sliding_block_cached__dense_activation_squared_relu__prompt_kernel_pld15
    s_sleep 1
    s_sub_u32 s71, s71, 1
    s_cmp_lg_u32 s71, 0
    s_cbranch_scc1 adaLN_cond__sliding_block_cached__dense_activation_squared_relu__prompt_kernel_pl14
adaLN_cond__sliding_block_cached__dense_activation_squared_relu__prompt_kernel_pld15:
    s_add_u32 s71, s82, 0
    buffer_load_dwordx4 v[32:35], v252, s[52:55], s71 offen sc1
    s_add_u32 s71, s82, 65536
    buffer_load_dwordx4 v[36:39], v252, s[52:55], s71 offen sc1
    s_add_u32 s71, s82, 131072
    buffer_load_dwordx4 v[40:43], v252, s[52:55], s71 offen sc1
    s_add_u32 s71, s82, 196608
    buffer_load_dwordx4 v[44:47], v252, s[52:55], s71 offen sc1
    s_add_u32 s71, s82, 262144
    buffer_load_dwordx4 v[48:51], v252, s[52:55], s71 offen sc1
    s_add_u32 s71, s82, 327680
    buffer_load_dwordx4 v[52:55], v252, s[52:55], s71 offen sc1
    s_add_u32 s71, s82, 393216
    buffer_load_dwordx4 v[56:59], v252, s[52:55], s71 offen sc1
    s_add_u32 s71, s82, 458752
    buffer_load_dwordx4 v[60:63], v252, s[52:55], s71 offen sc1
    ds_read_b64_tr_b16 v[224:225], v5 offset:4096
    ds_read_b64_tr_b16 v[226:227], v5 offset:4608
    ds_read_b64_tr_b16 v[228:229], v6 offset:4096
    ds_read_b64_tr_b16 v[230:231], v6 offset:4608
    ds_read_b64_tr_b16 v[232:233], v5 offset:6144
    ds_read_b64_tr_b16 v[234:235], v5 offset:6656
    ds_read_b64_tr_b16 v[236:237], v6 offset:6144
    ds_read_b64_tr_b16 v[238:239], v6 offset:6656
    ds_read_b64_tr_b16 v[128:129], v5 offset:8192
    ds_read_b64_tr_b16 v[130:131], v5 offset:8704
    ds_read_b64_tr_b16 v[132:133], v6 offset:8192
    ds_read_b64_tr_b16 v[134:135], v6 offset:8704
    s_waitcnt lgkmcnt(2)
    ds_read_b64_tr_b16 v[136:137], v5 offset:10240
    ds_read_b64_tr_b16 v[138:139], v5 offset:10752
    ds_read_b64_tr_b16 v[140:141], v6 offset:10240
    ds_read_b64_tr_b16 v[142:143], v6 offset:10752
    ds_read_b64_tr_b16 v[144:145], v5 offset:0
    ds_read_b64_tr_b16 v[146:147], v5 offset:512
    ds_read_b64_tr_b16 v[148:149], v6 offset:0
    ds_read_b64_tr_b16 v[150:151], v6 offset:512
    ds_read_b64_tr_b16 v[152:153], v5 offset:2048
    ds_read_b64_tr_b16 v[154:155], v5 offset:2560
    ds_read_b64_tr_b16 v[156:157], v6 offset:2048
    ds_read_b64_tr_b16 v[158:159], v6 offset:2560
    s_waitcnt lgkmcnt(2)
    s_waitcnt vmcnt(7)
    v_lshlrev_b32 v64, 16, v32
    v_and_b32 v65, s67, v32
    v_lshlrev_b32 v66, 16, v33
    v_and_b32 v67, s67, v33
    v_lshlrev_b32 v68, 16, v34
    v_and_b32 v69, s67, v34
    v_lshlrev_b32 v70, 16, v35
    v_and_b32 v71, s67, v35
    s_waitcnt vmcnt(6)
    v_lshlrev_b32 v72, 16, v36
    v_and_b32 v73, s67, v36
    v_lshlrev_b32 v74, 16, v37
    v_and_b32 v75, s67, v37
    v_lshlrev_b32 v76, 16, v38
    v_and_b32 v77, s67, v38
    v_lshlrev_b32 v78, 16, v39
    v_and_b32 v79, s67, v39
    v_pk_add_f32 v[64:65], v[64:65], v[72:73]
    v_pk_add_f32 v[66:67], v[66:67], v[74:75]
    v_pk_add_f32 v[68:69], v[68:69], v[76:77]
    v_pk_add_f32 v[70:71], v[70:71], v[78:79]
    s_waitcnt vmcnt(5)
    v_lshlrev_b32 v72, 16, v40
    v_and_b32 v73, s67, v40
    v_lshlrev_b32 v74, 16, v41
    v_and_b32 v75, s67, v41
    v_lshlrev_b32 v76, 16, v42
    v_and_b32 v77, s67, v42
    v_lshlrev_b32 v78, 16, v43
    v_and_b32 v79, s67, v43
    v_pk_add_f32 v[64:65], v[64:65], v[72:73]
    v_pk_add_f32 v[66:67], v[66:67], v[74:75]
    v_pk_add_f32 v[68:69], v[68:69], v[76:77]
    v_pk_add_f32 v[70:71], v[70:71], v[78:79]
    s_waitcnt vmcnt(4)
    v_lshlrev_b32 v72, 16, v44
    v_and_b32 v73, s67, v44
    v_lshlrev_b32 v74, 16, v45
    v_and_b32 v75, s67, v45
    v_lshlrev_b32 v76, 16, v46
    v_and_b32 v77, s67, v46
    v_lshlrev_b32 v78, 16, v47
    v_and_b32 v79, s67, v47
    v_pk_add_f32 v[64:65], v[64:65], v[72:73]
    v_pk_add_f32 v[66:67], v[66:67], v[74:75]
    v_pk_add_f32 v[68:69], v[68:69], v[76:77]
    v_pk_add_f32 v[70:71], v[70:71], v[78:79]
    s_waitcnt vmcnt(3)
    v_lshlrev_b32 v72, 16, v48
    v_and_b32 v73, s67, v48
    v_lshlrev_b32 v74, 16, v49
    v_and_b32 v75, s67, v49
    v_lshlrev_b32 v76, 16, v50
    v_and_b32 v77, s67, v50
    v_lshlrev_b32 v78, 16, v51
    v_and_b32 v79, s67, v51
    v_pk_add_f32 v[64:65], v[64:65], v[72:73]
    v_pk_add_f32 v[66:67], v[66:67], v[74:75]
    v_pk_add_f32 v[68:69], v[68:69], v[76:77]
    v_pk_add_f32 v[70:71], v[70:71], v[78:79]
    s_waitcnt vmcnt(2)
    v_lshlrev_b32 v72, 16, v52
    v_and_b32 v73, s67, v52
    v_lshlrev_b32 v74, 16, v53
    v_and_b32 v75, s67, v53
    v_lshlrev_b32 v76, 16, v54
    v_and_b32 v77, s67, v54
    v_lshlrev_b32 v78, 16, v55
    v_and_b32 v79, s67, v55
    v_pk_add_f32 v[64:65], v[64:65], v[72:73]
    v_pk_add_f32 v[66:67], v[66:67], v[74:75]
    v_pk_add_f32 v[68:69], v[68:69], v[76:77]
    v_pk_add_f32 v[70:71], v[70:71], v[78:79]
    s_waitcnt vmcnt(1)
    v_lshlrev_b32 v72, 16, v56
    v_and_b32 v73, s67, v56
    v_lshlrev_b32 v74, 16, v57
    v_and_b32 v75, s67, v57
    v_lshlrev_b32 v76, 16, v58
    v_and_b32 v77, s67, v58
    v_lshlrev_b32 v78, 16, v59
    v_and_b32 v79, s67, v59
    v_pk_add_f32 v[64:65], v[64:65], v[72:73]
    v_pk_add_f32 v[66:67], v[66:67], v[74:75]
    v_pk_add_f32 v[68:69], v[68:69], v[76:77]
    v_pk_add_f32 v[70:71], v[70:71], v[78:79]
    s_waitcnt vmcnt(0)
    v_lshlrev_b32 v72, 16, v60
    v_and_b32 v73, s67, v60
    v_lshlrev_b32 v74, 16, v61
    v_and_b32 v75, s67, v61
    v_lshlrev_b32 v76, 16, v62
    v_and_b32 v77, s67, v62
    v_lshlrev_b32 v78, 16, v63
    v_and_b32 v79, s67, v63
    v_pk_add_f32 v[64:65], v[64:65], v[72:73]
    v_pk_add_f32 v[66:67], v[66:67], v[74:75]
    v_pk_add_f32 v[68:69], v[68:69], v[76:77]
    v_pk_add_f32 v[70:71], v[70:71], v[78:79]
    v_cvt_pk_bf16_f32 v24, v64, v65
    v_lshlrev_b32 v64, 16, v24
    v_and_b32 v65, s67, v24
    v_cvt_pk_bf16_f32 v24, v66, v67
    v_lshlrev_b32 v66, 16, v24
    v_and_b32 v67, s67, v24
    v_cvt_pk_bf16_f32 v24, v68, v69
    v_lshlrev_b32 v68, 16, v24
    v_and_b32 v69, s67, v24
    v_cvt_pk_bf16_f32 v24, v70, v71
    v_lshlrev_b32 v70, 16, v24
    v_and_b32 v71, s67, v24
    v_pk_mul_f32 v[64:65], v[64:65], v[88:89]
    v_pk_mul_f32 v[66:67], v[66:67], v[90:91]
    v_pk_mul_f32 v[68:69], v[68:69], v[92:93]
    v_pk_mul_f32 v[70:71], v[70:71], v[94:95]
    v_cvt_pk_bf16_f32 v24, v64, v65
    v_lshlrev_b32 v64, 16, v24
    v_and_b32 v65, s67, v24
    v_cvt_pk_bf16_f32 v24, v66, v67
    v_lshlrev_b32 v66, 16, v24
    v_and_b32 v67, s67, v24
    v_cvt_pk_bf16_f32 v24, v68, v69
    v_lshlrev_b32 v68, 16, v24
    v_and_b32 v69, s67, v24
    v_cvt_pk_bf16_f32 v24, v70, v71
    v_lshlrev_b32 v70, 16, v24
    v_and_b32 v71, s67, v24
    v_pk_add_f32 v[64:65], v[64:65], v[80:81]
    v_pk_add_f32 v[66:67], v[66:67], v[82:83]
    v_pk_add_f32 v[68:69], v[68:69], v[84:85]
    v_pk_add_f32 v[70:71], v[70:71], v[86:87]
    v_cvt_pk_bf16_f32 v240, v64, v65
    v_lshlrev_b32 v64, 16, v240
    v_and_b32 v65, s67, v240
    v_cvt_pk_bf16_f32 v241, v66, v67
    v_lshlrev_b32 v66, 16, v241
    v_and_b32 v67, s67, v241
    v_cvt_pk_bf16_f32 v242, v68, v69
    v_lshlrev_b32 v68, 16, v242
    v_and_b32 v69, s67, v242
    v_cvt_pk_bf16_f32 v243, v70, v71
    v_lshlrev_b32 v70, 16, v243
    v_and_b32 v71, s67, v243
    v_pk_add_f32 v[72:73], v[64:65], v[66:67]
    v_pk_mul_f32 v[74:75], v[64:65], v[64:65]
    v_pk_add_f32 v[72:73], v[72:73], v[68:69]
    v_pk_add_f32 v[72:73], v[72:73], v[70:71]
    v_pk_fma_f32 v[74:75], v[66:67], v[66:67], v[74:75]
    v_pk_fma_f32 v[74:75], v[68:69], v[68:69], v[74:75]
    v_pk_fma_f32 v[74:75], v[70:71], v[70:71], v[74:75]
    v_add_f32 v26, v72, v73
    v_add_f32 v27, v74, v75
    s_nop 0
    v_add_f32_dpp v26, v26, v26 row_ror:8 row_mask:0xf bank_mask:0xf
    v_add_f32_dpp v27, v27, v27 row_ror:8 row_mask:0xf bank_mask:0xf
    v_pk_mov_b32 v[24:25], v[26:27], v[26:27] op_sel:[0,1]
    s_nop 1
    v_permlane16_swap_b32 v26, v24
    v_permlane16_swap_b32 v27, v25
    v_pk_add_f32 v[26:27], v[26:27], v[24:25]
    v_pk_mov_b32 v[24:25], v[26:27], v[26:27] op_sel:[0,1]
    s_nop 1
    v_permlane32_swap_b32 v26, v24
    v_permlane32_swap_b32 v27, v25
    v_pk_add_f32 v[26:27], v[26:27], v[24:25]
    ds_write_b64 v12, v[26:27]
    s_waitcnt lgkmcnt(0)
    s_barrier
    ds_read_b128 v[32:35], v13 offset:0
    ds_read_b128 v[36:39], v13 offset:16
    ds_read_b128 v[40:43], v13 offset:32
    ds_read_b128 v[44:47], v13 offset:48
    s_waitcnt lgkmcnt(0)
    v_pk_add_f32 v[32:33], v[32:33], v[40:41]
    v_pk_add_f32 v[34:35], v[34:35], v[42:43]
    v_pk_add_f32 v[36:37], v[36:37], v[44:45]
    v_pk_add_f32 v[38:39], v[38:39], v[46:47]
    v_pk_add_f32 v[32:33], v[32:33], v[36:37]
    v_pk_add_f32 v[34:35], v[34:35], v[38:39]
    v_pk_add_f32 v[32:33], v[32:33], v[34:35]
    s_mov_b32 s71, 989855744
    v_mul_f32 v32, s71, v32
    v_mul_f32 v33, s71, v33
    v_fma_f32 v33, -v32, v32, v33
    v_max_f32 v33, 0, v33
    v_cvt_pk_bf16_f32 v34, v32, v33
    v_lshlrev_b32 v32, 16, v34
    v_and_b32 v33, s67, v34
    v_add_f32 v33, 925353388, v33
    v_cvt_pk_bf16_f32 v33, v33, v33
    v_and_b32 v33, s67, v33
    v_sqrt_f32 v33, v33
    s_nop 0
    v_cvt_pk_bf16_f32 v33, v33, v33
    v_and_b32 v33, s67, v33
    v_rcp_f32 v34, v33
    s_nop 0
    v_mul_f32 v35, -v32, v34
    v_pk_fma_f32 v[64:65], v[64:65], v[34:35], v[34:35] op_sel:[0,0,1] op_sel_hi:[1,0,1]
    v_pk_fma_f32 v[66:67], v[66:67], v[34:35], v[34:35] op_sel:[0,0,1] op_sel_hi:[1,0,1]
    v_pk_fma_f32 v[68:69], v[68:69], v[34:35], v[34:35] op_sel:[0,0,1] op_sel_hi:[1,0,1]
    v_pk_fma_f32 v[70:71], v[70:71], v[34:35], v[34:35] op_sel:[0,0,1] op_sel_hi:[1,0,1]
    v_pk_fma_f32 v[64:65], v[64:65], v[104:105], v[96:97]
    v_pk_fma_f32 v[66:67], v[66:67], v[106:107], v[98:99]
    v_pk_fma_f32 v[68:69], v[68:69], v[108:109], v[100:101]
    v_pk_fma_f32 v[70:71], v[70:71], v[110:111], v[102:103]
    v_cvt_pk_bf16_f32 v72, v64, v65
    v_cvt_pk_bf16_f32 v73, v66, v67
    v_cvt_pk_bf16_f32 v74, v68, v69
    v_cvt_pk_bf16_f32 v75, v70, v71
    s_add_u32 s72, s82, 65536
    s_cmp_eq_u32 s34, 0
    s_cbranch_scc1 adaLN_cond__sliding_block_cached__dense_activation_squared_relu__prompt_kernel_du16
    buffer_store_dwordx4 v[72:75], v252, s[52:55], s82 offen
    buffer_store_dwordx4 v[240:243], v252, s[52:55], s72 offen
    s_branch adaLN_cond__sliding_block_cached__dense_activation_squared_relu__prompt_kernel_du17
adaLN_cond__sliding_block_cached__dense_activation_squared_relu__prompt_kernel_du16:
    buffer_store_dwordx4 v[72:75], v252, s[52:55], s82 offen sc1
    buffer_store_dwordx4 v[240:243], v252, s[52:55], s72 offen sc1
adaLN_cond__sliding_block_cached__dense_activation_squared_relu__prompt_kernel_du17:
    s_lshl_b32 s73, s65, 4
    s_and_b32 s71, s64, 1
    s_add_u32 s73, s73, s71
    s_lshl_b32 s73, s73, 15
    s_lshr_b32 s71, s64, 1
    s_lshl_b32 s71, s71, 10
    s_add_u32 s73, s73, s71
    s_lshl_b32 s76, s64, 10
    s_lshl_b32 s78, s65, 19
    s_add_u32 s78, s78, 65536
    s_lshr_b32 s72, s64, 2
    s_lshl_b32 s72, s72, 15
    s_add_u32 s78, s78, s72
    s_lshl_b32 s72, s66, 12
    s_add_u32 s78, s78, s72
    s_and_b32 s72, s64, 3
    s_lshl_b32 s72, s72, 10
    s_add_u32 s78, s78, s72
    s_lshl_b32 s77, s65, 19
    s_add_u32 s77, s77, 131072
    s_mul_i32 s71, s64, 28672
    s_add_u32 s79, s77, s71
    s_mul_i32 s71, s66, 28672
    s_add_u32 s77, s77, s71
    s_lshl_b32 s71, s64, 12
    s_add_u32 s77, s77, s71
    v_mov_b32 v9, 1
    s_waitcnt vmcnt(0)
    s_cmp_eq_u32 s34, 0
    s_cbranch_scc1 adaLN_cond__sliding_block_cached__dense_activation_squared_relu__prompt_kernel_du18
    buffer_store_dword v9, v255, s[60:63], s81 offen offset:512
    s_branch adaLN_cond__sliding_block_cached__dense_activation_squared_relu__prompt_kernel_du19
adaLN_cond__sliding_block_cached__dense_activation_squared_relu__prompt_kernel_du18:
    buffer_store_dword v9, v255, s[60:63], s81 offen offset:512 sc1
adaLN_cond__sliding_block_cached__dense_activation_squared_relu__prompt_kernel_du19:
    s_cmp_eq_u32 s64, 7
    s_cbranch_scc1 K_w7a
    s_add_u32 m0, s85, 0
    s_nop 0
    buffer_load_dwordx4 v2, s[44:47], s70 offen lds
    s_add_u32 s70, s70, 57344
    s_add_u32 m0, s85, 7168
    s_nop 0
    buffer_load_dwordx4 v2, s[44:47], s70 offen lds
    s_add_u32 s70, s70, 57344
    s_add_u32 m0, s85, 14336
    s_nop 0
    buffer_load_dwordx4 v2, s[44:47], s70 offen lds
    s_add_u32 s70, s70, 57344
    s_add_u32 m0, s85, 21504
    s_nop 0
    buffer_load_dwordx4 v2, s[44:47], s70 offen lds
    s_add_u32 s70, s70, 57344
    s_add_u32 m0, s85, 28672
    s_nop 0
    buffer_load_dwordx4 v2, s[44:47], s70 offen lds
    s_add_u32 s70, s70, 57344
    s_add_u32 m0, s85, 35840
    s_nop 0
    buffer_load_dwordx4 v2, s[44:47], s70 offen lds
    s_add_u32 s70, s70, 57344
    s_add_u32 m0, s85, 43008
    s_nop 0
    buffer_load_dwordx4 v2, s[44:47], s70 offen lds
    s_add_u32 s70, s70, 57344
    s_add_u32 m0, s85, 50176
    s_nop 0
    buffer_load_dwordx4 v2, s[44:47], s70 offen lds
    s_add_u32 s70, s70, 57344
K_w7a:
    v_lshlrev_b32 v10, 2, v0
    s_mov_b32 s71, 40000
adaLN_cond__sliding_block_cached__dense_activation_squared_relu__prompt_kernel_pl20:
    buffer_load_dword v9, v10, s[60:63], s35 offen offset:512 sc1
    s_waitcnt vmcnt(0)
    v_cmp_ne_u32 vcc, 0, v9
    s_nop 0
    s_cmp_eq_u64 vcc, -1
    s_cbranch_scc1 adaLN_cond__sliding_block_cached__dense_activation_squared_relu__prompt_kernel_pld21
    s_sleep 1
    s_sub_u32 s71, s71, 1
    s_cmp_lg_u32 s71, 0
    s_cbranch_scc1 adaLN_cond__sliding_block_cached__dense_activation_squared_relu__prompt_kernel_pl20
adaLN_cond__sliding_block_cached__dense_activation_squared_relu__prompt_kernel_pld21:
    s_add_u32 m0, s76, 0
    s_add_u32 s71, s73, 0
    buffer_load_dwordx4 v21, s[52:55], s71 offen sc1 lds
    s_add_u32 m0, s76, 8192
    s_add_u32 s71, s73, 4096
    buffer_load_dwordx4 v21, s[52:55], s71 offen sc1 lds
    s_add_u32 m0, s76, 16384
    s_add_u32 s71, s73, 8192
    buffer_load_dwordx4 v21, s[52:55], s71 offen sc1 lds
    s_cmp_eq_u32 s64, 7
    s_cbranch_scc1 K_w7c
    s_waitcnt vmcnt(2)
    s_barrier
    ds_read_b64_tr_b16 v[32:33], v3 offset:0
    ds_read_b64_tr_b16 v[34:35], v3 offset:1792
    ds_read_b128 v[36:39], v21 offset:0
    ds_read_b128 v[40:43], v21 offset:1024
    ds_read_b64_tr_b16 v[44:45], v3 offset:7168
    ds_read_b64_tr_b16 v[46:47], v3 offset:8960
    ds_read_b128 v[48:51], v21 offset:2048
    ds_read_b128 v[52:55], v21 offset:3072
    s_waitcnt lgkmcnt(4)
    s_add_u32 m0, s76, 24576
    s_add_u32 s71, s73, 12288
    buffer_load_dwordx4 v21, s[52:55], s71 offen sc1 lds
    v_mfma_f32_32x32x16_bf16 v[64:79], v[32:35], v[36:39], 0
    v_mfma_f32_32x32x16_bf16 v[80:95], v[32:35], v[40:43], 0
    ds_read_b64_tr_b16 v[32:33], v3 offset:14336
    ds_read_b64_tr_b16 v[34:35], v3 offset:16128
    ds_read_b128 v[36:39], v21 offset:4096
    ds_read_b128 v[40:43], v21 offset:5120
    s_waitcnt lgkmcnt(4)
    s_add_u32 m0, s85, 57344
    s_nop 0
    buffer_load_dwordx4 v2, s[44:47], s70 offen lds
    s_add_u32 s70, s70, 57344
    s_add_u32 m0, s85, 64512
    s_nop 0
    buffer_load_dwordx4 v2, s[44:47], s70 offen lds
    s_add_u32 s70, s70, 57344
    s_add_u32 m0, s85, 71680
    s_nop 0
    buffer_load_dwordx4 v2, s[44:47], s70 offen lds
    s_add_u32 s70, s70, 57344
    s_add_u32 m0, s85, 78848
    s_nop 0
    buffer_load_dwordx4 v2, s[44:47], s70 offen lds
    s_add_u32 s70, s70, 57344
    v_mfma_f32_32x32x16_bf16 v[64:79], v[44:47], v[48:51], v[64:79]
    v_mfma_f32_32x32x16_bf16 v[80:95], v[44:47], v[52:55], v[80:95]
    ds_read_b64_tr_b16 v[44:45], v3 offset:21504
    ds_read_b64_tr_b16 v[46:47], v3 offset:23296
    ds_read_b128 v[48:51], v21 offset:6144
    ds_read_b128 v[52:55], v21 offset:7168
    s_waitcnt lgkmcnt(4)
    s_add_u32 m0, s76, 32768
    s_add_u32 s71, s73, 16384
    buffer_load_dwordx4 v21, s[52:55], s71 offen sc1 lds
    v_mfma_f32_32x32x16_bf16 v[64:79], v[32:35], v[36:39], v[64:79]
    v_mfma_f32_32x32x16_bf16 v[80:95], v[32:35], v[40:43], v[80:95]
    s_waitcnt lgkmcnt(0)
    s_waitcnt vmcnt(7)
    s_barrier
    ds_read_b64_tr_b16 v[32:33], v3 offset:28672
    ds_read_b64_tr_b16 v[34:35], v3 offset:30464
    ds_read_b128 v[36:39], v21 offset:8192
    ds_read_b128 v[40:43], v21 offset:9216
    s_add_u32 m0, s85, 0
    s_nop 0
    buffer_load_dwordx4 v2, s[44:47], s70 offen lds
    s_add_u32 s70, s70, 57344
    s_add_u32 m0, s85, 7168
    s_nop 0
    buffer_load_dwordx4 v2, s[44:47], s70 offen lds
    s_add_u32 s70, s70, 57344
    s_add_u32 m0, s85, 14336
    s_nop 0
    buffer_load_dwordx4 v2, s[44:47], s70 offen lds
    s_add_u32 s70, s70, 57344
    s_add_u32 m0, s85, 21504
    s_nop 0
    buffer_load_dwordx4 v2, s[44:47], s70 offen lds
    s_add_u32 s70, s70, 57344
    v_mfma_f32_32x32x16_bf16 v[64:79], v[44:47], v[48:51], v[64:79]
    v_mfma_f32_32x32x16_bf16 v[80:95], v[44:47], v[52:55], v[80:95]
    ds_read_b64_tr_b16 v[44:45], v3 offset:35840
    ds_read_b64_tr_b16 v[46:47], v3 offset:37632
    ds_read_b128 v[48:51], v21 offset:10240
    ds_read_b128 v[52:55], v21 offset:11264
    s_waitcnt lgkmcnt(4)
    s_add_u32 m0, s76, 40960
    s_add_u32 s71, s73, 20480
    buffer_load_dwordx4 v21, s[52:55], s71 offen sc1 lds
    v_mfma_f32_32x32x16_bf16 v[64:79], v[32:35], v[36:39], v[64:79]
    v_mfma_f32_32x32x16_bf16 v[80:95], v[32:35], v[40:43], v[80:95]
    ds_read_b64_tr_b16 v[32:33], v4 offset:0
    ds_read_b64_tr_b16 v[34:35], v4 offset:1792
    ds_read_b128 v[36:39], v21 offset:12288
    ds_read_b128 v[40:43], v21 offset:13312
    s_waitcnt lgkmcnt(4)
    s_add_u32 m0, s76, 49152
    s_add_u32 s71, s73, 24576
    buffer_load_dwordx4 v21, s[52:55], s71 offen sc1 lds
    v_mfma_f32_32x32x16_bf16 v[64:79], v[44:47], v[48:51], v[64:79]
    v_mfma_f32_32x32x16_bf16 v[80:95], v[44:47], v[52:55], v[80:95]
    ds_read_b64_tr_b16 v[44:45], v4 offset:7168
    ds_read_b64_tr_b16 v[46:47], v4 offset:8960
    ds_read_b128 v[48:51], v21 offset:14336
    ds_read_b128 v[52:55], v21 offset:15360
    s_waitcnt lgkmcnt(4)
    s_add_u32 m0, s76, 57344
    s_add_u32 s71, s73, 28672
    buffer_load_dwordx4 v21, s[52:55], s71 offen sc1 lds
    v_mfma_f32_32x32x16_bf16 v[64:79], v[32:35], v[36:39], v[64:79]
    v_mfma_f32_32x32x16_bf16 v[80:95], v[32:35], v[40:43], v[80:95]
    s_waitcnt lgkmcnt(0)
    s_waitcnt vmcnt(8)
    s_barrier
    ds_read_b64_tr_b16 v[32:33], v4 offset:14336
    ds_read_b64_tr_b16 v[34:35], v4 offset:16128
    ds_read_b128 v[36:39], v21 offset:16384
    ds_read_b128 v[40:43], v21 offset:17408
    s_add_u32 m0, s85, 28672
    s_nop 0
    buffer_load_dwordx4 v2, s[44:47], s70 offen lds
    s_add_u32 s70, s70, 57344
    s_add_u32 m0, s85, 35840
    s_nop 0
    buffer_load_dwordx4 v2, s[44:47], s70 offen lds
    s_add_u32 s70, s70, 57344
    s_add_u32 m0, s85, 43008
    s_nop 0
    buffer_load_dwordx4 v2, s[44:47], s70 offen lds
    s_add_u32 s70, s70, 57344
    s_add_u32 m0, s85, 50176
    s_nop 0
    buffer_load_dwordx4 v2, s[44:47], s70 offen lds
    s_add_u32 s70, s70, 57344
    v_mfma_f32_32x32x16_bf16 v[64:79], v[44:47], v[48:51], v[64:79]
    v_mfma_f32_32x32x16_bf16 v[80:95], v[44:47], v[52:55], v[80:95]
    ds_read_b64_tr_b16 v[44:45], v4 offset:21504
    ds_read_b64_tr_b16 v[46:47], v4 offset:23296
    ds_read_b128 v[48:51], v21 offset:18432
    ds_read_b128 v[52:55], v21 offset:19456
    s_waitcnt lgkmcnt(4)
    buffer_load_dwordx4 v[240:243], v21, s[52:55], s78 offen sc1
    v_mfma_f32_32x32x16_bf16 v[64:79], v[32:35], v[36:39], v[64:79]
    v_mfma_f32_32x32x16_bf16 v[80:95], v[32:35], v[40:43], v[80:95]
    ds_read_b64_tr_b16 v[32:33], v4 offset:28672
    ds_read_b64_tr_b16 v[34:35], v4 offset:30464
    ds_read_b128 v[36:39], v21 offset:20480
    ds_read_b128 v[40:43], v21 offset:21504
    s_waitcnt lgkmcnt(4)
    v_mfma_f32_32x32x16_bf16 v[64:79], v[44:47], v[48:51], v[64:79]
    v_mfma_f32_32x32x16_bf16 v[80:95], v[44:47], v[52:55], v[80:95]
    ds_read_b64_tr_b16 v[44:45], v4 offset:35840
    ds_read_b64_tr_b16 v[46:47], v4 offset:37632
    ds_read_b128 v[48:51], v21 offset:22528
    ds_read_b128 v[52:55], v21 offset:23552
    s_waitcnt lgkmcnt(4)
    v_mfma_f32_32x32x16_bf16 v[64:79], v[32:35], v[36:39], v[64:79]
    v_mfma_f32_32x32x16_bf16 v[80:95], v[32:35], v[40:43], v[80:95]
    s_waitcnt lgkmcnt(0)
    s_waitcnt vmcnt(8)
    s_barrier
    ds_read_b64_tr_b16 v[32:33], v3 offset:0
    ds_read_b64_tr_b16 v[34:35], v3 offset:1792
    ds_read_b128 v[36:39], v21 offset:24576
    ds_read_b128 v[40:43], v21 offset:25600
    s_add_u32 m0, s85, 57344
    s_nop 0
    buffer_load_dwordx4 v2, s[44:47], s70 offen lds
    s_add_u32 s70, s70, 57344
    s_add_u32 m0, s85, 64512
    s_nop 0
    buffer_load_dwordx4 v2, s[44:47], s70 offen lds
    s_add_u32 s70, s70, 57344
    s_add_u32 m0, s85, 71680
    s_nop 0
    buffer_load_dwordx4 v2, s[44:47], s70 offen lds
    s_add_u32 s70, s70, 57344
    s_add_u32 m0, s85, 78848
    s_nop 0
    buffer_load_dwordx4 v2, s[44:47], s70 offen lds
    s_add_u32 s70, s70, 57344
    v_mfma_f32_32x32x16_bf16 v[64:79], v[44:47], v[48:51], v[64:79]
    v_mfma_f32_32x32x16_bf16 v[80:95], v[44:47], v[52:55], v[80:95]
    ds_read_b64_tr_b16 v[44:45], v3 offset:7168
    ds_read_b64_tr_b16 v[46:47], v3 offset:8960
    ds_read_b128 v[48:51], v21 offset:26624
    ds_read_b128 v[52:55], v21 offset:27648
    s_waitcnt lgkmcnt(4)
    v_mfma_f32_32x32x16_bf16 v[64:79], v[32:35], v[36:39], v[64:79]
    v_mfma_f32_32x32x16_bf16 v[80:95], v[32:35], v[40:43], v[80:95]
    ds_read_b64_tr_b16 v[32:33], v3 offset:14336
    ds_read_b64_tr_b16 v[34:35], v3 offset:16128
    ds_read_b128 v[36:39], v21 offset:28672
    ds_read_b128 v[40:43], v21 offset:29696
    s_waitcnt lgkmcnt(4)
    v_mfma_f32_32x32x16_bf16 v[64:79], v[44:47], v[48:51], v[64:79]
    v_mfma_f32_32x32x16_bf16 v[80:95], v[44:47], v[52:55], v[80:95]
    ds_read_b64_tr_b16 v[44:45], v3 offset:21504
    ds_read_b64_tr_b16 v[46:47], v3 offset:23296
    ds_read_b128 v[48:51], v21 offset:30720
    ds_read_b128 v[52:55], v21 offset:31744
    s_waitcnt lgkmcnt(4)
    v_mfma_f32_32x32x16_bf16 v[64:79], v[32:35], v[36:39], v[64:79]
    v_mfma_f32_32x32x16_bf16 v[80:95], v[32:35], v[40:43], v[80:95]
    s_waitcnt lgkmcnt(0)
    s_waitcnt vmcnt(5)
    s_barrier
    ds_read_b64_tr_b16 v[32:33], v3 offset:28672
    ds_read_b64_tr_b16 v[34:35], v3 offset:30464
    ds_read_b128 v[36:39], v21 offset:32768
    ds_read_b128 v[40:43], v21 offset:33792
    s_add_u32 m0, s85, 0
    s_nop 0
    buffer_load_dwordx4 v2, s[44:47], s70 offen lds
    s_add_u32 s70, s70, 57344
    s_add_u32 m0, s85, 7168
    s_nop 0
    buffer_load_dwordx4 v2, s[44:47], s70 offen lds
    s_add_u32 s70, s70, 57344
    s_add_u32 m0, s85, 14336
    s_nop 0
    buffer_load_dwordx4 v2, s[44:47], s70 offen lds
    s_add_u32 s70, s70, 57344
    s_add_u32 m0, s85, 21504
    s_nop 0
    buffer_load_dwordx4 v2, s[44:47], s70 offen lds
    s_add_u32 s70, s70, 57344
    v_mfma_f32_32x32x16_bf16 v[64:79], v[44:47], v[48:51], v[64:79]
    v_mfma_f32_32x32x16_bf16 v[80:95], v[44:47], v[52:55], v[80:95]
    ds_read_b64_tr_b16 v[44:45], v3 offset:35840
    ds_read_b64_tr_b16 v[46:47], v3 offset:37632
    ds_read_b128 v[48:51], v21 offset:34816
    ds_read_b128 v[52:55], v21 offset:35840
    s_waitcnt lgkmcnt(4)
    v_mfma_f32_32x32x16_bf16 v[64:79], v[32:35], v[36:39], v[64:79]
    v_mfma_f32_32x32x16_bf16 v[80:95], v[32:35], v[40:43], v[80:95]
    ds_read_b64_tr_b16 v[32:33], v4 offset:0
    ds_read_b64_tr_b16 v[34:35], v4 offset:1792
    ds_read_b128 v[36:39], v21 offset:36864
    ds_read_b128 v[40:43], v21 offset:37888
    s_waitcnt lgkmcnt(4)
    v_mfma_f32_32x32x16_bf16 v[64:79], v[44:47], v[48:51], v[64:79]
    v_mfma_f32_32x32x16_bf16 v[80:95], v[44:47], v[52:55], v[80:95]
    ds_read_b64_tr_b16 v[44:45], v4 offset:7168
    ds_read_b64_tr_b16 v[46:47], v4 offset:8960
    ds_read_b128 v[48:51], v21 offset:38912
    ds_read_b128 v[52:55], v21 offset:39936
    s_waitcnt lgkmcnt(4)
    v_mfma_f32_32x32x16_bf16 v[64:79], v[32:35], v[36:39], v[64:79]
    v_mfma_f32_32x32x16_bf16 v[80:95], v[32:35], v[40:43], v[80:95]
    s_waitcnt lgkmcnt(0)
    s_waitcnt vmcnt(4)
    s_barrier
    ds_read_b64_tr_b16 v[32:33], v4 offset:14336
    ds_read_b64_tr_b16 v[34:35], v4 offset:16128
    ds_read_b128 v[36:39], v21 offset:40960
    ds_read_b128 v[40:43], v21 offset:41984
    s_add_u32 m0, s85, 28672
    s_nop 0
    buffer_load_dwordx4 v2, s[44:47], s70 offen lds
    s_add_u32 s70, s70, 57344
    s_add_u32 m0, s85, 35840
    s_nop 0
    buffer_load_dwordx4 v2, s[44:47], s70 offen lds
    s_add_u32 s70, s70, 57344
    s_add_u32 m0, s85, 43008
    s_nop 0
    buffer_load_dwordx4 v2, s[44:47], s70 offen lds
    s_add_u32 s70, s70, 57344
    s_add_u32 m0, s85, 50176
    s_nop 0
    buffer_load_dwordx4 v2, s[44:47], s70 offen lds
    s_add_u32 s70, s70, 57344
    v_mfma_f32_32x32x16_bf16 v[64:79], v[44:47], v[48:51], v[64:79]
    v_mfma_f32_32x32x16_bf16 v[80:95], v[44:47], v[52:55], v[80:95]
    ds_read_b64_tr_b16 v[44:45], v4 offset:21504
    ds_read_b64_tr_b16 v[46:47], v4 offset:23296
    ds_read_b128 v[48:51], v21 offset:43008
    ds_read_b128 v[52:55], v21 offset:44032
    s_waitcnt lgkmcnt(4)
    v_and_b32 v10, 31, v0
    v_lshlrev_b32 v10, 7, v10
    buffer_load_dword v11, v10, s[52:55], s77 offen sc1
    v_mfma_f32_32x32x16_bf16 v[64:79], v[32:35], v[36:39], v[64:79]
    v_mfma_f32_32x32x16_bf16 v[80:95], v[32:35], v[40:43], v[80:95]
    ds_read_b64_tr_b16 v[32:33], v4 offset:28672
    ds_read_b64_tr_b16 v[34:35], v4 offset:30464
    ds_read_b128 v[36:39], v21 offset:45056
    ds_read_b128 v[40:43], v21 offset:46080
    s_waitcnt lgkmcnt(4)
    v_mfma_f32_32x32x16_bf16 v[64:79], v[44:47], v[48:51], v[64:79]
    v_mfma_f32_32x32x16_bf16 v[80:95], v[44:47], v[52:55], v[80:95]
    ds_read_b64_tr_b16 v[44:45], v4 offset:35840
    ds_read_b64_tr_b16 v[46:47], v4 offset:37632
    ds_read_b128 v[48:51], v21 offset:47104
    ds_read_b128 v[52:55], v21 offset:48128
    s_waitcnt lgkmcnt(4)
    v_mfma_f32_32x32x16_bf16 v[64:79], v[32:35], v[36:39], v[64:79]
    v_mfma_f32_32x32x16_bf16 v[80:95], v[32:35], v[40:43], v[80:95]
    s_waitcnt lgkmcnt(0)
    s_waitcnt vmcnt(5)
    s_barrier
    ds_read_b64_tr_b16 v[32:33], v3 offset:0
    ds_read_b64_tr_b16 v[34:35], v3 offset:1792
    ds_read_b128 v[36:39], v21 offset:49152
    ds_read_b128 v[40:43], v21 offset:50176
    v_mfma_f32_32x32x16_bf16 v[64:79], v[44:47], v[48:51], v[64:79]
    v_mfma_f32_32x32x16_bf16 v[80:95], v[44:47], v[52:55], v[80:95]
    ds_read_b64_tr_b16 v[44:45], v3 offset:7168
    ds_read_b64_tr_b16 v[46:47], v3 offset:8960
    ds_read_b128 v[48:51], v21 offset:51200
    ds_read_b128 v[52:55], v21 offset:52224
    s_waitcnt lgkmcnt(4)
    v_mfma_f32_32x32x16_bf16 v[64:79], v[32:35], v[36:39], v[64:79]
    v_mfma_f32_32x32x16_bf16 v[80:95], v[32:35], v[40:43], v[80:95]
    ds_read_b64_tr_b16 v[32:33], v3 offset:14336
    ds_read_b64_tr_b16 v[34:35], v3 offset:16128
    ds_read_b128 v[36:39], v21 offset:53248
    ds_read_b128 v[40:43], v21 offset:54272
    s_waitcnt lgkmcnt(4)
    v_mfma_f32_32x32x16_bf16 v[64:79], v[44:47], v[48:51], v[64:79]
    v_mfma_f32_32x32x16_bf16 v[80:95], v[44:47], v[52:55], v[80:95]
    ds_read_b64_tr_b16 v[44:45], v3 offset:21504
    ds_read_b64_tr_b16 v[46:47], v3 offset:23296
    ds_read_b128 v[48:51], v21 offset:55296
    ds_read_b128 v[52:55], v21 offset:56320
    s_waitcnt lgkmcnt(4)
    v_mfma_f32_32x32x16_bf16 v[64:79], v[32:35], v[36:39], v[64:79]
    v_mfma_f32_32x32x16_bf16 v[80:95], v[32:35], v[40:43], v[80:95]
    s_waitcnt lgkmcnt(0)
    s_waitcnt vmcnt(1)
    s_barrier
    ds_read_b64_tr_b16 v[32:33], v3 offset:28672
    ds_read_b64_tr_b16 v[34:35], v3 offset:30464
    ds_read_b128 v[36:39], v21 offset:57344
    ds_read_b128 v[40:43], v21 offset:58368
    v_mfma_f32_32x32x16_bf16 v[64:79], v[44:47], v[48:51], v[64:79]
    v_mfma_f32_32x32x16_bf16 v[80:95], v[44:47], v[52:55], v[80:95]
    ds_read_b64_tr_b16 v[44:45], v3 offset:35840
    ds_read_b64_tr_b16 v[46:47], v3 offset:37632
    ds_read_b128 v[48:51], v21 offset:59392
    ds_read_b128 v[52:55], v21 offset:60416
    s_waitcnt lgkmcnt(4)
    v_mfma_f32_32x32x16_bf16 v[64:79], v[32:35], v[36:39], v[64:79]
    v_mfma_f32_32x32x16_bf16 v[80:95], v[32:35], v[40:43], v[80:95]
    ds_read_b64_tr_b16 v[32:33], v4 offset:0
    ds_read_b64_tr_b16 v[34:35], v4 offset:1792
    ds_read_b128 v[36:39], v21 offset:61440
    ds_read_b128 v[40:43], v21 offset:62464
    s_waitcnt lgkmcnt(4)
    v_mfma_f32_32x32x16_bf16 v[64:79], v[44:47], v[48:51], v[64:79]
    v_mfma_f32_32x32x16_bf16 v[80:95], v[44:47], v[52:55], v[80:95]
    ds_read_b64_tr_b16 v[44:45], v4 offset:7168
    ds_read_b64_tr_b16 v[46:47], v4 offset:8960
    ds_read_b128 v[48:51], v21 offset:63488
    ds_read_b128 v[52:55], v21 offset:64512
    s_waitcnt lgkmcnt(4)
    v_mfma_f32_32x32x16_bf16 v[64:79], v[32:35], v[36:39], v[64:79]
    v_mfma_f32_32x32x16_bf16 v[80:95], v[32:35], v[40:43], v[80:95]
    s_waitcnt lgkmcnt(0)
    v_mfma_f32_32x32x16_bf16 v[64:79], v[44:47], v[48:51], v[64:79]
    v_mfma_f32_32x32x16_bf16 v[80:95], v[44:47], v[52:55], v[80:95]
    s_nop 10
    v_pk_add_f32 v[64:65], v[64:65], v[112:113]
    v_pk_add_f32 v[66:67], v[66:67], v[114:115]
    v_pk_add_f32 v[68:69], v[68:69], v[116:117]
    v_pk_add_f32 v[70:71], v[70:71], v[118:119]
    v_max_f32 v64, 0, v64
    v_max_f32 v65, 0, v65
    v_max_f32 v66, 0, v66
    v_max_f32 v67, 0, v67
    v_max_f32 v68, 0, v68
    v_max_f32 v69, 0, v69
    v_max_f32 v70, 0, v70
    v_max_f32 v71, 0, v71
    v_pk_mul_f32 v[64:65], v[64:65], v[64:65]
    v_pk_mul_f32 v[66:67], v[66:67], v[66:67]
    v_pk_mul_f32 v[68:69], v[68:69], v[68:69]
    v_pk_mul_f32 v[70:71], v[70:71], v[70:71]
    v_cvt_pk_bf16_f32 v96, v64, v65
    v_cvt_pk_bf16_f32 v97, v66, v67
    v_cvt_pk_bf16_f32 v98, v68, v69
    v_cvt_pk_bf16_f32 v99, v70, v71
    v_pk_add_f32 v[72:73], v[72:73], v[120:121]
    v_pk_add_f32 v[74:75], v[74:75], v[122:123]
    v_pk_add_f32 v[76:77], v[76:77], v[124:125]
    v_pk_add_f32 v[78:79], v[78:79], v[126:127]
    v_max_f32 v72, 0, v72
    v_max_f32 v73, 0, v73
    v_max_f32 v74, 0, v74
    v_max_f32 v75, 0, v75
    v_max_f32 v76, 0, v76
    v_max_f32 v77, 0, v77
    v_max_f32 v78, 0, v78
    v_max_f32 v79, 0, v79
    v_pk_mul_f32 v[72:73], v[72:73], v[72:73]
    v_pk_mul_f32 v[74:75], v[74:75], v[74:75]
    v_pk_mul_f32 v[76:77], v[76:77], v[76:77]
    v_pk_mul_f32 v[78:79], v[78:79], v[78:79]
    v_cvt_pk_bf16_f32 v104, v72, v73
    v_cvt_pk_bf16_f32 v105, v74, v75
    v_cvt_pk_bf16_f32 v106, v76, v77
    v_cvt_pk_bf16_f32 v107, v78, v79
    v_pk_add_f32 v[80:81], v[80:81], v[112:113]
    v_pk_add_f32 v[82:83], v[82:83], v[114:115]
    v_pk_add_f32 v[84:85], v[84:85], v[116:117]
    v_pk_add_f32 v[86:87], v[86:87], v[118:119]
    v_max_f32 v80, 0, v80
    v_max_f32 v81, 0, v81
    v_max_f32 v82, 0, v82
    v_max_f32 v83, 0, v83
    v_max_f32 v84, 0, v84
    v_max_f32 v85, 0, v85
    v_max_f32 v86, 0, v86
    v_max_f32 v87, 0, v87
    v_pk_mul_f32 v[80:81], v[80:81], v[80:81]
    v_pk_mul_f32 v[82:83], v[82:83], v[82:83]
    v_pk_mul_f32 v[84:85], v[84:85], v[84:85]
    v_pk_mul_f32 v[86:87], v[86:87], v[86:87]
    v_cvt_pk_bf16_f32 v100, v80, v81
    v_cvt_pk_bf16_f32 v101, v82, v83
    v_cvt_pk_bf16_f32 v102, v84, v85
    v_cvt_pk_bf16_f32 v103, v86, v87
    v_pk_add_f32 v[88:89], v[88:89], v[120:121]
    v_pk_add_f32 v[90:91], v[90:91], v[122:123]
    v_pk_add_f32 v[92:93], v[92:93], v[124:125]
    v_pk_add_f32 v[94:95], v[94:95], v[126:127]
    v_max_f32 v88, 0, v88
    v_max_f32 v89, 0, v89
    v_max_f32 v90, 0, v90
    v_max_f32 v91, 0, v91
    v_max_f32 v92, 0, v92
    v_max_f32 v93, 0, v93
    v_max_f32 v94, 0, v94
    v_max_f32 v95, 0, v95
    v_pk_mul_f32 v[88:89], v[88:89], v[88:89]
    v_pk_mul_f32 v[90:91], v[90:91], v[90:91]
    v_pk_mul_f32 v[92:93], v[92:93], v[92:93]
    v_pk_mul_f32 v[94:95], v[94:95], v[94:95]
    v_cvt_pk_bf16_f32 v108, v88, v89
    v_cvt_pk_bf16_f32 v109, v90, v91
    v_cvt_pk_bf16_f32 v110, v92, v93
    v_cvt_pk_bf16_f32 v111, v94, v95
    s_cmp_eq_u32 s34, 0
    s_cbranch_scc1 adaLN_cond__sliding_block_cached__dense_activation_squared_relu__prompt_kernel_du22
    buffer_store_dwordx4 v[96:99], v21, s[52:55], s77 offen offset:0
    buffer_store_dwordx4 v[100:103], v21, s[52:55], s77 offen offset:1024
    buffer_store_dwordx4 v[104:107], v21, s[52:55], s77 offen offset:2048
    buffer_store_dwordx4 v[108:111], v21, s[52:55], s77 offen offset:3072
    s_branch adaLN_cond__sliding_block_cached__dense_activation_squared_relu__prompt_kernel_du23
adaLN_cond__sliding_block_cached__dense_activation_squared_relu__prompt_kernel_du22:
    buffer_store_dwordx4 v[96:99], v21, s[52:55], s77 offen offset:0 sc1
    buffer_store_dwordx4 v[100:103], v21, s[52:55], s77 offen offset:1024 sc1
    buffer_store_dwordx4 v[104:107], v21, s[52:55], s77 offen offset:2048 sc1
    buffer_store_dwordx4 v[108:111], v21, s[52:55], s77 offen offset:3072 sc1
adaLN_cond__sliding_block_cached__dense_activation_squared_relu__prompt_kernel_du23:
    s_branch K_fj
K_w7c:
    s_add_u32 m0, s76, 24576
    s_add_u32 s71, s73, 12288
    buffer_load_dwordx4 v21, s[52:55], s71 offen sc1 lds
    s_add_u32 m0, s76, 32768
    s_add_u32 s71, s73, 16384
    buffer_load_dwordx4 v21, s[52:55], s71 offen sc1 lds
    s_add_u32 m0, s76, 40960
    s_add_u32 s71, s73, 20480
    buffer_load_dwordx4 v21, s[52:55], s71 offen sc1 lds
    s_add_u32 m0, s76, 49152
    s_add_u32 s71, s73, 24576
    buffer_load_dwordx4 v21, s[52:55], s71 offen sc1 lds
    s_add_u32 m0, s76, 57344
    s_add_u32 s71, s73, 28672
    buffer_load_dwordx4 v21, s[52:55], s71 offen sc1 lds
    buffer_load_dwordx4 v[240:243], v21, s[52:55], s78 offen sc1
    s_waitcnt vmcnt(8)
    s_barrier
    s_waitcnt vmcnt(7)
    s_barrier
    s_waitcnt vmcnt(6)
    s_barrier
    s_waitcnt vmcnt(5)
    s_barrier
    s_waitcnt vmcnt(4)
    s_barrier
    s_waitcnt vmcnt(3)
    s_barrier
    s_waitcnt vmcnt(2)
    s_barrier
    s_waitcnt vmcnt(1)
    s_barrier
K_fj:
    s_lshl_b32 s71, s64, 2
    v_lshlrev_b32 v10, 3, v254
    v_add_u32 v10, s71, v10
    v_mov_b32 v9, 1
    s_waitcnt vmcnt(0)
    s_cmp_eq_u32 s34, 0
    s_cbranch_scc1 adaLN_cond__sliding_block_cached__dense_activation_squared_relu__prompt_kernel_du24
    buffer_store_dword v9, v255, s[60:63], s81 offen offset:768
    s_branch adaLN_cond__sliding_block_cached__dense_activation_squared_relu__prompt_kernel_du25
adaLN_cond__sliding_block_cached__dense_activation_squared_relu__prompt_kernel_du24:
    buffer_store_dword v9, v255, s[60:63], s81 offen offset:768 sc1
adaLN_cond__sliding_block_cached__dense_activation_squared_relu__prompt_kernel_du25:
    s_barrier
    s_mov_b32 s71, 40000
adaLN_cond__sliding_block_cached__dense_activation_squared_relu__prompt_kernel_pl26:
    buffer_load_dword v9, v10, s[60:63], s35 offen offset:768 sc1
    s_waitcnt vmcnt(0)
    v_cmp_ne_u32 vcc, 0, v9
    s_nop 0
    s_cmp_eq_u64 vcc, -1
    s_cbranch_scc1 adaLN_cond__sliding_block_cached__dense_activation_squared_relu__prompt_kernel_pld27
    s_sleep 1
    s_sub_u32 s71, s71, 1
    s_cmp_lg_u32 s71, 0
    s_cbranch_scc1 adaLN_cond__sliding_block_cached__dense_activation_squared_relu__prompt_kernel_pl26
adaLN_cond__sliding_block_cached__dense_activation_squared_relu__prompt_kernel_pld27:
    buffer_load_dwordx4 v[32:35], v21, s[52:55], s79 offen offset:0 sc1
    buffer_load_dwordx4 v[36:39], v21, s[52:55], s79 offen offset:1024 sc1
    buffer_load_dwordx4 v[40:43], v21, s[52:55], s79 offen offset:2048 sc1
    buffer_load_dwordx4 v[44:47], v21, s[52:55], s79 offen offset:3072 sc1
    s_add_u32 s79, s79, 4096
    buffer_load_dwordx4 v[48:51], v21, s[52:55], s79 offen offset:0 sc1
    buffer_load_dwordx4 v[52:55], v21, s[52:55], s79 offen offset:1024 sc1
    buffer_load_dwordx4 v[56:59], v21, s[52:55], s79 offen offset:2048 sc1
    buffer_load_dwordx4 v[60:63], v21, s[52:55], s79 offen offset:3072 sc1
    s_waitcnt vmcnt(6)
    v_mfma_f32_32x32x16_bf16 v[64:79], v[160:163], v[32:35], 0
    v_mfma_f32_32x32x16_bf16 v[80:95], v[164:167], v[32:35], 0
    v_mfma_f32_32x32x16_bf16 v[96:111], v[160:163], v[36:39], 0
    v_mfma_f32_32x32x16_bf16 v[112:127], v[164:167], v[36:39], 0
    s_add_u32 s79, s79, 4096
    buffer_load_dwordx4 v[32:35], v21, s[52:55], s79 offen offset:0 sc1
    buffer_load_dwordx4 v[36:39], v21, s[52:55], s79 offen offset:1024 sc1
    s_waitcnt vmcnt(6)
    v_mfma_f32_32x32x16_bf16 v[64:79], v[168:171], v[40:43], v[64:79]
    v_mfma_f32_32x32x16_bf16 v[80:95], v[172:175], v[40:43], v[80:95]
    v_mfma_f32_32x32x16_bf16 v[96:111], v[168:171], v[44:47], v[96:111]
    v_mfma_f32_32x32x16_bf16 v[112:127], v[172:175], v[44:47], v[112:127]
    buffer_load_dwordx4 v[40:43], v21, s[52:55], s79 offen offset:2048 sc1
    buffer_load_dwordx4 v[44:47], v21, s[52:55], s79 offen offset:3072 sc1
    s_waitcnt vmcnt(6)
    v_mfma_f32_32x32x16_bf16 v[64:79], v[176:179], v[48:51], v[64:79]
    v_mfma_f32_32x32x16_bf16 v[80:95], v[180:183], v[48:51], v[80:95]
    v_mfma_f32_32x32x16_bf16 v[96:111], v[176:179], v[52:55], v[96:111]
    v_mfma_f32_32x32x16_bf16 v[112:127], v[180:183], v[52:55], v[112:127]
    s_add_u32 s79, s79, 4096
    buffer_load_dwordx4 v[48:51], v21, s[52:55], s79 offen offset:0 sc1
    buffer_load_dwordx4 v[52:55], v21, s[52:55], s79 offen offset:1024 sc1
    s_waitcnt vmcnt(6)
    v_mfma_f32_32x32x16_bf16 v[64:79], v[184:187], v[56:59], v[64:79]
    v_mfma_f32_32x32x16_bf16 v[80:95], v[188:191], v[56:59], v[80:95]
    v_mfma_f32_32x32x16_bf16 v[96:111], v[184:187], v[60:63], v[96:111]
    v_mfma_f32_32x32x16_bf16 v[112:127], v[188:191], v[60:63], v[112:127]
    buffer_load_dwordx4 v[56:59], v21, s[52:55], s79 offen offset:2048 sc1
    buffer_load_dwordx4 v[60:63], v21, s[52:55], s79 offen offset:3072 sc1
    s_waitcnt vmcnt(6)
    v_mfma_f32_32x32x16_bf16 v[64:79], v[192:195], v[32:35], v[64:79]
    v_mfma_f32_32x32x16_bf16 v[80:95], v[196:199], v[32:35], v[80:95]
    v_mfma_f32_32x32x16_bf16 v[96:111], v[192:195], v[36:39], v[96:111]
    v_mfma_f32_32x32x16_bf16 v[112:127], v[196:199], v[36:39], v[112:127]
    s_add_u32 s79, s79, 4096
    buffer_load_dwordx4 v[32:35], v21, s[52:55], s79 offen offset:0 sc1
    buffer_load_dwordx4 v[36:39], v21, s[52:55], s79 offen offset:1024 sc1
    s_waitcnt vmcnt(6)
    v_mfma_f32_32x32x16_bf16 v[64:79], v[200:203], v[40:43], v[64:79]
    v_mfma_f32_32x32x16_bf16 v[80:95], v[204:207], v[40:43], v[80:95]
    v_mfma_f32_32x32x16_bf16 v[96:111], v[200:203], v[44:47], v[96:111]
    v_mfma_f32_32x32x16_bf16 v[112:127], v[204:207], v[44:47], v[112:127]
    buffer_load_dwordx4 v[40:43], v21, s[52:55], s79 offen offset:2048 sc1
    buffer_load_dwordx4 v[44:47], v21, s[52:55], s79 offen offset:3072 sc1
    s_waitcnt vmcnt(6)
    v_mfma_f32_32x32x16_bf16 v[64:79], v[208:211], v[48:51], v[64:79]
    v_mfma_f32_32x32x16_bf16 v[80:95], v[212:215], v[48:51], v[80:95]
    v_mfma_f32_32x32x16_bf16 v[96:111], v[208:211], v[52:55], v[96:111]
    v_mfma_f32_32x32x16_bf16 v[112:127], v[212:215], v[52:55], v[112:127]
    s_add_u32 s79, s79, 4096
    buffer_load_dwordx4 v[48:51], v21, s[52:55], s79 offen offset:0 sc1
    buffer_load_dwordx4 v[52:55], v21, s[52:55], s79 offen offset:1024 sc1
    s_waitcnt vmcnt(6)
    v_mfma_f32_32x32x16_bf16 v[64:79], v[216:219], v[56:59], v[64:79]
    v_mfma_f32_32x32x16_bf16 v[80:95], v[220:223], v[56:59], v[80:95]
    v_mfma_f32_32x32x16_bf16 v[96:111], v[216:219], v[60:63], v[96:111]
    v_mfma_f32_32x32x16_bf16 v[112:127], v[220:223], v[60:63], v[112:127]
    buffer_load_dwordx4 v[56:59], v21, s[52:55], s79 offen offset:2048 sc1
    buffer_load_dwordx4 v[60:63], v21, s[52:55], s79 offen offset:3072 sc1
    s_waitcnt vmcnt(6)
    v_mfma_f32_32x32x16_bf16 v[64:79], v[224:227], v[32:35], v[64:79]
    v_mfma_f32_32x32x16_bf16 v[80:95], v[228:231], v[32:35], v[80:95]
    v_mfma_f32_32x32x16_bf16 v[96:111], v[224:227], v[36:39], v[96:111]
    v_mfma_f32_32x32x16_bf16 v[112:127], v[228:231], v[36:39], v[112:127]
    s_add_u32 s79, s79, 4096
    buffer_load_dwordx4 v[32:35], v21, s[52:55], s79 offen offset:0 sc1
    buffer_load_dwordx4 v[36:39], v21, s[52:55], s79 offen offset:1024 sc1
    s_waitcnt vmcnt(6)
    v_mfma_f32_32x32x16_bf16 v[64:79], v[232:235], v[40:43], v[64:79]
    v_mfma_f32_32x32x16_bf16 v[80:95], v[236:239], v[40:43], v[80:95]
    v_mfma_f32_32x32x16_bf16 v[96:111], v[232:235], v[44:47], v[96:111]
    v_mfma_f32_32x32x16_bf16 v[112:127], v[236:239], v[44:47], v[112:127]
    buffer_load_dwordx4 v[40:43], v21, s[52:55], s79 offen offset:2048 sc1
    buffer_load_dwordx4 v[44:47], v21, s[52:55], s79 offen offset:3072 sc1
    s_waitcnt vmcnt(6)
    v_mfma_f32_32x32x16_bf16 v[64:79], v[128:131], v[48:51], v[64:79]
    v_mfma_f32_32x32x16_bf16 v[80:95], v[132:135], v[48:51], v[80:95]
    v_mfma_f32_32x32x16_bf16 v[96:111], v[128:131], v[52:55], v[96:111]
    v_mfma_f32_32x32x16_bf16 v[112:127], v[132:135], v[52:55], v[112:127]
    s_waitcnt vmcnt(4)
    v_mfma_f32_32x32x16_bf16 v[64:79], v[136:139], v[56:59], v[64:79]
    v_mfma_f32_32x32x16_bf16 v[80:95], v[140:143], v[56:59], v[80:95]
    v_mfma_f32_32x32x16_bf16 v[96:111], v[136:139], v[60:63], v[96:111]
    v_mfma_f32_32x32x16_bf16 v[112:127], v[140:143], v[60:63], v[112:127]
    s_waitcnt vmcnt(2)
    v_mfma_f32_32x32x16_bf16 v[64:79], v[144:147], v[32:35], v[64:79]
    v_mfma_f32_32x32x16_bf16 v[80:95], v[148:151], v[32:35], v[80:95]
    v_mfma_f32_32x32x16_bf16 v[96:111], v[144:147], v[36:39], v[96:111]
    v_mfma_f32_32x32x16_bf16 v[112:127], v[148:151], v[36:39], v[112:127]
    s_waitcnt vmcnt(0)
    v_mfma_f32_32x32x16_bf16 v[64:79], v[152:155], v[40:43], v[64:79]
    v_mfma_f32_32x32x16_bf16 v[80:95], v[156:159], v[40:43], v[80:95]
    v_mfma_f32_32x32x16_bf16 v[96:111], v[152:155], v[44:47], v[96:111]
    v_mfma_f32_32x32x16_bf16 v[112:127], v[156:159], v[44:47], v[112:127]
    s_lshl_b32 s71, s64, 14
    v_add_u32 v10, s71, v21
    s_lshl_b32 s71, s64, 11
    v_add_u32 v11, s71, v21
    v_add_u32 v12, 0x10000, v11
    v_lshlrev_b32 v32, 16, v240
    v_and_b32 v33, s67, v240
    v_lshlrev_b32 v40, 16, v244
    v_and_b32 v41, s67, v244
    v_lshlrev_b32 v48, 16, v248
    v_and_b32 v49, s67, v248
    v_lshlrev_b32 v34, 16, v241
    v_and_b32 v35, s67, v241
    v_lshlrev_b32 v42, 16, v245
    v_and_b32 v43, s67, v245
    v_lshlrev_b32 v50, 16, v249
    v_and_b32 v51, s67, v249
    v_lshlrev_b32 v36, 16, v242
    v_and_b32 v37, s67, v242
    v_lshlrev_b32 v44, 16, v246
    v_and_b32 v45, s67, v246
    v_lshlrev_b32 v52, 16, v250
    v_and_b32 v53, s67, v250
    v_lshlrev_b32 v38, 16, v243
    v_and_b32 v39, s67, v243
    v_lshlrev_b32 v46, 16, v247
    v_and_b32 v47, s67, v247
    v_lshlrev_b32 v54, 16, v251
    v_and_b32 v55, s67, v251
    ds_write_b128 v10, v[64:67] offset:0
    ds_write_b128 v10, v[68:71] offset:1024
    ds_write_b128 v10, v[72:75] offset:2048
    ds_write_b128 v10, v[76:79] offset:3072
    ds_write_b128 v10, v[80:83] offset:4096
    ds_write_b128 v10, v[84:87] offset:5120
    ds_write_b128 v10, v[88:91] offset:6144
    ds_write_b128 v10, v[92:95] offset:7168
    ds_write_b128 v10, v[96:99] offset:8192
    ds_write_b128 v10, v[100:103] offset:9216
    ds_write_b128 v10, v[104:107] offset:10240
    ds_write_b128 v10, v[108:111] offset:11264
    ds_write_b128 v10, v[112:115] offset:12288
    ds_write_b128 v10, v[116:119] offset:13312
    ds_write_b128 v10, v[120:123] offset:14336
    ds_write_b128 v10, v[124:127] offset:15360
    s_waitcnt lgkmcnt(0)
    s_barrier
    ds_read_b128 v[128:131], v11 offset:0
    ds_read_b128 v[132:135], v11 offset:1024
    ds_read_b128 v[136:139], v11 offset:16384
    ds_read_b128 v[140:143], v11 offset:17408
    ds_read_b128 v[144:147], v11 offset:32768
    ds_read_b128 v[148:151], v11 offset:33792
    ds_read_b128 v[152:155], v11 offset:49152
    ds_read_b128 v[156:159], v11 offset:50176
    s_waitcnt lgkmcnt(0)
    ds_read_b128 v[160:163], v12 offset:0
    ds_read_b128 v[164:167], v12 offset:1024
    ds_read_b128 v[168:171], v12 offset:16384
    ds_read_b128 v[172:175], v12 offset:17408
    ds_read_b128 v[176:179], v12 offset:32768
    ds_read_b128 v[180:183], v12 offset:33792
    ds_read_b128 v[184:187], v12 offset:49152
    ds_read_b128 v[188:191], v12 offset:50176
    s_waitcnt lgkmcnt(0)
    v_pk_add_f32 v[128:129], v[128:129], v[160:161]
    v_pk_add_f32 v[130:131], v[130:131], v[162:163]
    v_pk_add_f32 v[132:133], v[132:133], v[164:165]
    v_pk_add_f32 v[134:135], v[134:135], v[166:167]
    v_pk_add_f32 v[136:137], v[136:137], v[168:169]
    v_pk_add_f32 v[138:139], v[138:139], v[170:171]
    v_pk_add_f32 v[140:141], v[140:141], v[172:173]
    v_pk_add_f32 v[142:143], v[142:143], v[174:175]
    v_pk_add_f32 v[144:145], v[144:145], v[176:177]
    v_pk_add_f32 v[146:147], v[146:147], v[178:179]
    v_pk_add_f32 v[148:149], v[148:149], v[180:181]
    v_pk_add_f32 v[150:151], v[150:151], v[182:183]
    v_pk_add_f32 v[152:153], v[152:153], v[184:185]
    v_pk_add_f32 v[154:155], v[154:155], v[186:187]
    v_pk_add_f32 v[156:157], v[156:157], v[188:189]
    v_pk_add_f32 v[158:159], v[158:159], v[190:191]
    v_pk_add_f32 v[128:129], v[128:129], v[144:145]
    v_pk_add_f32 v[130:131], v[130:131], v[146:147]
    v_pk_add_f32 v[132:133], v[132:133], v[148:149]
    v_pk_add_f32 v[134:135], v[134:135], v[150:151]
    v_pk_add_f32 v[136:137], v[136:137], v[152:153]
    v_pk_add_f32 v[138:139], v[138:139], v[154:155]
    v_pk_add_f32 v[140:141], v[140:141], v[156:157]
    v_pk_add_f32 v[142:143], v[142:143], v[158:159]
    v_pk_add_f32 v[128:129], v[128:129], v[136:137]
    v_pk_add_f32 v[130:131], v[130:131], v[138:139]
    v_pk_add_f32 v[132:133], v[132:133], v[140:141]
    v_pk_add_f32 v[134:135], v[134:135], v[142:143]
    v_cvt_pk_bf16_f32 v24, v128, v129
    v_lshlrev_b32 v128, 16, v24
    v_and_b32 v129, s67, v24
    v_cvt_pk_bf16_f32 v24, v130, v131
    v_lshlrev_b32 v130, 16, v24
    v_and_b32 v131, s67, v24
    v_cvt_pk_bf16_f32 v24, v132, v133
    v_lshlrev_b32 v132, 16, v24
    v_and_b32 v133, s67, v24
    v_cvt_pk_bf16_f32 v24, v134, v135
    v_lshlrev_b32 v134, 16, v24
    v_and_b32 v135, s67, v24
    v_pk_add_f32 v[128:129], v[128:129], v[48:49]
    v_pk_add_f32 v[130:131], v[130:131], v[50:51]
    v_pk_add_f32 v[132:133], v[132:133], v[52:53]
    v_pk_add_f32 v[134:135], v[134:135], v[54:55]
    v_cvt_pk_bf16_f32 v24, v128, v129
    v_lshlrev_b32 v128, 16, v24
    v_and_b32 v129, s67, v24
    v_cvt_pk_bf16_f32 v24, v130, v131
    v_lshlrev_b32 v130, 16, v24
    v_and_b32 v131, s67, v24
    v_cvt_pk_bf16_f32 v24, v132, v133
    v_lshlrev_b32 v132, 16, v24
    v_and_b32 v133, s67, v24
    v_cvt_pk_bf16_f32 v24, v134, v135
    v_lshlrev_b32 v134, 16, v24
    v_and_b32 v135, s67, v24
    v_pk_mul_f32 v[128:129], v[128:129], v[40:41]
    v_pk_mul_f32 v[130:131], v[130:131], v[42:43]
    v_pk_mul_f32 v[132:133], v[132:133], v[44:45]
    v_pk_mul_f32 v[134:135], v[134:135], v[46:47]
    v_cvt_pk_bf16_f32 v24, v128, v129
    v_lshlrev_b32 v128, 16, v24
    v_and_b32 v129, s67, v24
    v_cvt_pk_bf16_f32 v24, v130, v131
    v_lshlrev_b32 v130, 16, v24
    v_and_b32 v131, s67, v24
    v_cvt_pk_bf16_f32 v24, v132, v133
    v_lshlrev_b32 v132, 16, v24
    v_and_b32 v133, s67, v24
    v_cvt_pk_bf16_f32 v24, v134, v135
    v_lshlrev_b32 v134, 16, v24
    v_and_b32 v135, s67, v24
    v_pk_add_f32 v[128:129], v[128:129], v[32:33]
    v_pk_add_f32 v[130:131], v[130:131], v[34:35]
    v_pk_add_f32 v[132:133], v[132:133], v[36:37]
    v_pk_add_f32 v[134:135], v[134:135], v[38:39]
    v_cvt_pk_bf16_f32 v136, v128, v129
    v_cvt_pk_bf16_f32 v137, v130, v131
    v_cvt_pk_bf16_f32 v138, v132, v133
    v_cvt_pk_bf16_f32 v139, v134, v135
    buffer_store_dwordx4 v[136:139], v253, s[40:43], 0 offen
K_end:
    s_endpgm
K_slow:
    s_nop 15
    s_waitcnt vmcnt(0) lgkmcnt(0)
    v_subrev_u32 v24, s68, v15
    v_xor_b32 v25, 16, v24
    v_xor_b32 v26, 32, v24
    v_xor_b32 v27, 48, v24
    v_and_b32 v5, 0x7fff, v5
    v_add_u32 v5, s69, v5
    v_and_b32 v6, 0x7fff, v6
    v_add_u32 v6, s69, v6
    v_and_b32 v7, 0x7fff, v7
    v_add_u32 v7, s69, v7
    v_and_b32 v8, 0x7fff, v8
    v_add_u32 v8, s69, v8
    v_and_b32 v9, 0x7fff, v9
    v_add_u32 v9, s69, v9
    v_and_b32 v10, 0x7fff, v10
    v_add_u32 v10, s69, v10
    v_and_b32 v11, 0x7fff, v11
    v_add_u32 v11, s69, v11
    v_and_b32 v12, 0x7fff, v12
    v_add_u32 v12, s69, v12
    v_and_b32 v1, 0x7fff, v1
    v_add_u32 v1, s69, v1
    v_and_b32 v2, 0x7fff, v2
    v_add_u32 v2, s69, v2
    v_and_b32 v3, 0x7fff, v3
    v_add_u32 v3, s69, v3
    v_and_b32 v4, 0x7fff, v4
    v_add_u32 v4, s69, v4
    v_mov_b32 v28, 0xff800000
    v_mov_b32 v30, v34
    s_mov_b32 s73, 0
K_s1:
    s_add_u32 m0, s69, 0
    s_add_u32 s76, s73, 0
    buffer_load_dwordx4 v24, s[36:39], s76 offen offset:0 lds
    buffer_load_dwordx4 v25, s[36:39], s76 offen offset:1024 lds
    buffer_load_dwordx4 v26, s[36:39], s76 offen offset:2048 lds
    buffer_load_dwordx4 v27, s[36:39], s76 offen offset:3072 lds
    s_add_u32 m0, s69, 4096
    s_add_u32 s76, s73, 4096
    buffer_load_dwordx4 v24, s[36:39], s76 offen offset:0 lds
    buffer_load_dwordx4 v25, s[36:39], s76 offen offset:1024 lds
    buffer_load_dwordx4 v26, s[36:39], s76 offen offset:2048 lds
    buffer_load_dwordx4 v27, s[36:39], s76 offen offset:3072 lds
    s_waitcnt vmcnt(0)
    ds_read_b128 v[96:99], v5
    ds_read_b128 v[100:103], v6
    ds_read_b128 v[104:107], v7
    ds_read_b128 v[108:111], v8
    ds_read_b128 v[112:115], v9
    ds_read_b128 v[116:119], v10
    ds_read_b128 v[120:123], v11
    ds_read_b128 v[124:127], v12
    s_waitcnt lgkmcnt(0)
    v_mfma_f32_32x32x16_bf16 v[32:47], v[96:99], v[160:163], 0
    v_mfma_f32_32x32x16_bf16 v[32:47], v[100:103], v[164:167], v[32:47]
    v_mfma_f32_32x32x16_bf16 v[32:47], v[104:107], v[168:171], v[32:47]
    v_mfma_f32_32x32x16_bf16 v[32:47], v[108:111], v[172:175], v[32:47]
    v_mfma_f32_32x32x16_bf16 v[32:47], v[112:115], v[176:179], v[32:47]
    v_mfma_f32_32x32x16_bf16 v[32:47], v[116:119], v[180:183], v[32:47]
    v_mfma_f32_32x32x16_bf16 v[32:47], v[120:123], v[184:187], v[32:47]
    v_mfma_f32_32x32x16_bf16 v[32:47], v[124:127], v[188:191], v[32:47]
    s_nop 11
    v_max3_f32 v28, v28, v32, v33
    v_max3_f32 v28, v28, v34, v35
    v_max3_f32 v28, v28, v36, v37
    v_max3_f32 v28, v28, v38, v39
    v_max3_f32 v28, v28, v40, v41
    v_max3_f32 v28, v28, v42, v43
    v_max3_f32 v28, v28, v44, v45
    v_max3_f32 v28, v28, v46, v47
    s_add_u32 s73, s73, 8192
    s_cmp_lt_u32 s73, 131072
    s_cbranch_scc1 K_s1
    v_mov_b32 v29, v28
    s_nop 1
    v_permlane32_swap_b32 v28, v29
    v_max_f32 v28, v28, v29
    v_sub_f32 v80, 0, v28
    v_sub_f32 v81, 0, v28
    v_sub_f32 v82, 0, v28
    v_sub_f32 v83, 0, v28
    v_sub_f32 v84, 0, v28
    v_sub_f32 v85, 0, v28
    v_sub_f32 v86, 0, v28
    v_sub_f32 v87, 0, v28
    v_sub_f32 v88, 0, v28
    v_sub_f32 v89, 0, v28
    v_sub_f32 v90, 0, v28
    v_sub_f32 v91, 0, v28
    v_sub_f32 v92, 0, v28
    v_sub_f32 v93, 0, v28
    v_sub_f32 v94, 0, v28
    v_sub_f32 v95, 0, v28
    v_mov_b32 v192, 0
    v_mov_b32 v193, 0
    v_mov_b32 v194, 0
    v_mov_b32 v195, 0
    v_mov_b32 v196, 0
    v_mov_b32 v197, 0
    v_mov_b32 v198, 0
    v_mov_b32 v199, 0
    v_mov_b32 v200, 0
    v_mov_b32 v201, 0
    v_mov_b32 v202, 0
    v_mov_b32 v203, 0
    v_mov_b32 v204, 0
    v_mov_b32 v205, 0
    v_mov_b32 v206, 0
    v_mov_b32 v207, 0
    v_mov_b32 v208, 0
    v_mov_b32 v209, 0
    v_mov_b32 v210, 0
    v_mov_b32 v211, 0
    v_mov_b32 v212, 0
    v_mov_b32 v213, 0
    v_mov_b32 v214, 0
    v_mov_b32 v215, 0
    v_mov_b32 v216, 0
    v_mov_b32 v217, 0
    v_mov_b32 v218, 0
    v_mov_b32 v219, 0
    v_mov_b32 v220, 0
    v_mov_b32 v221, 0
    v_mov_b32 v222, 0
    v_mov_b32 v223, 0
    v_mov_b32 v224, 0
    v_mov_b32 v225, 0
    v_mov_b32 v226, 0
    v_mov_b32 v227, 0
    v_mov_b32 v228, 0
    v_mov_b32 v229, 0
    v_mov_b32 v230, 0
    v_mov_b32 v231, 0
    v_mov_b32 v232, 0
    v_mov_b32 v233, 0
    v_mov_b32 v234, 0
    v_mov_b32 v235, 0
    v_mov_b32 v236, 0
    v_mov_b32 v237, 0
    v_mov_b32 v238, 0
    v_mov_b32 v239, 0
    v_mov_b32 v240, 0
    v_mov_b32 v241, 0
    v_mov_b32 v242, 0
    v_mov_b32 v243, 0
    v_mov_b32 v244, 0
    v_mov_b32 v245, 0
    v_mov_b32 v246, 0
    v_mov_b32 v247, 0
    v_mov_b32 v248, 0
    v_mov_b32 v249, 0
    v_mov_b32 v250, 0
    v_mov_b32 v251, 0
    v_mov_b32 v252, 0
    v_mov_b32 v253, 0
    v_mov_b32 v254, 0
    v_mov_b32 v255, 0
    v_mov_b32 v17, 0
    v_mov_b32 v18, 0
    v_mov_b32 v19, 0
    v_mov_b32 v20, 0
    s_mov_b32 s73, 0
K_s2:
    s_add_u32 m0, s69, 0
    s_add_u32 s76, s73, 0
    buffer_load_dwordx4 v24, s[36:39], s76 offen offset:0 lds
    buffer_load_dwordx4 v25, s[36:39], s76 offen offset:1024 lds
    buffer_load_dwordx4 v26, s[36:39], s76 offen offset:2048 lds
    buffer_load_dwordx4 v27, s[36:39], s76 offen offset:3072 lds
    s_add_u32 m0, s69, 4096
    s_add_u32 s76, s73, 4096
    buffer_load_dwordx4 v24, s[36:39], s76 offen offset:0 lds
    buffer_load_dwordx4 v25, s[36:39], s76 offen offset:1024 lds
    buffer_load_dwordx4 v26, s[36:39], s76 offen offset:2048 lds
    buffer_load_dwordx4 v27, s[36:39], s76 offen offset:3072 lds
    s_waitcnt vmcnt(0)
    ds_read_b128 v[96:99], v5
    ds_read_b128 v[100:103], v6
    ds_read_b128 v[104:107], v7
    ds_read_b128 v[108:111], v8
    ds_read_b128 v[112:115], v9
    ds_read_b128 v[116:119], v10
    ds_read_b128 v[120:123], v11
    ds_read_b128 v[124:127], v12
    s_waitcnt lgkmcnt(0)
    v_mfma_f32_32x32x16_bf16 v[32:47], v[96:99], v[160:163], v[80:95]
    v_mfma_f32_32x32x16_bf16 v[32:47], v[100:103], v[164:167], v[32:47]
    v_mfma_f32_32x32x16_bf16 v[32:47], v[104:107], v[168:171], v[32:47]
    v_mfma_f32_32x32x16_bf16 v[32:47], v[108:111], v[172:175], v[32:47]
    v_mfma_f32_32x32x16_bf16 v[32:47], v[112:115], v[176:179], v[32:47]
    v_mfma_f32_32x32x16_bf16 v[32:47], v[116:119], v[180:183], v[32:47]
    v_mfma_f32_32x32x16_bf16 v[32:47], v[120:123], v[184:187], v[32:47]
    v_mfma_f32_32x32x16_bf16 v[32:47], v[124:127], v[188:191], v[32:47]
    s_add_u32 m0, s69, 0
    s_add_u32 s76, s73, 0
    buffer_load_dwordx4 v24, s[40:43], s76 offen offset:0 lds
    buffer_load_dwordx4 v24, s[40:43], s76 offen offset:1024 lds
    buffer_load_dwordx4 v24, s[40:43], s76 offen offset:2048 lds
    buffer_load_dwordx4 v24, s[40:43], s76 offen offset:3072 lds
    s_add_u32 m0, s69, 4096
    s_add_u32 s76, s73, 4096
    buffer_load_dwordx4 v24, s[40:43], s76 offen offset:0 lds
    buffer_load_dwordx4 v24, s[40:43], s76 offen offset:1024 lds
    buffer_load_dwordx4 v24, s[40:43], s76 offen offset:2048 lds
    buffer_load_dwordx4 v24, s[40:43], s76 offen offset:3072 lds
    s_waitcnt vmcnt(0)
    v_exp_f32 v32, v32
    v_exp_f32 v33, v33
    v_add_f32 v17, v17, v32
    v_exp_f32 v34, v34
    v_add_f32 v18, v18, v33
    v_cvt_pk_bf16_f32 v64, v32, v33
    v_exp_f32 v35, v35
    v_add_f32 v19, v19, v34
    v_exp_f32 v36, v36
    v_add_f32 v20, v20, v35
    v_cvt_pk_bf16_f32 v65, v34, v35
    v_exp_f32 v37, v37
    v_add_f32 v17, v17, v36
    v_exp_f32 v38, v38
    v_add_f32 v18, v18, v37
    v_cvt_pk_bf16_f32 v66, v36, v37
    v_exp_f32 v39, v39
    v_add_f32 v19, v19, v38
    v_exp_f32 v40, v40
    v_add_f32 v20, v20, v39
    v_cvt_pk_bf16_f32 v67, v38, v39
    v_exp_f32 v41, v41
    v_add_f32 v17, v17, v40
    v_exp_f32 v42, v42
    v_add_f32 v18, v18, v41
    v_cvt_pk_bf16_f32 v68, v40, v41
    v_exp_f32 v43, v43
    v_add_f32 v19, v19, v42
    v_exp_f32 v44, v44
    v_add_f32 v20, v20, v43
    v_cvt_pk_bf16_f32 v69, v42, v43
    v_exp_f32 v45, v45
    v_add_f32 v17, v17, v44
    v_exp_f32 v46, v46
    v_add_f32 v18, v18, v45
    v_cvt_pk_bf16_f32 v70, v44, v45
    v_exp_f32 v47, v47
    v_add_f32 v19, v19, v46
    v_add_f32 v20, v20, v47
    v_cvt_pk_bf16_f32 v71, v46, v47
    ds_read_b64_tr_b16 v[128:129], v1 offset:0
    ds_read_b64_tr_b16 v[130:131], v1 offset:1024
    ds_read_b64_tr_b16 v[132:133], v2 offset:0
    ds_read_b64_tr_b16 v[134:135], v2 offset:1024
    ds_read_b64_tr_b16 v[136:137], v3 offset:0
    ds_read_b64_tr_b16 v[138:139], v3 offset:1024
    ds_read_b64_tr_b16 v[140:141], v4 offset:0
    ds_read_b64_tr_b16 v[142:143], v4 offset:1024
    s_waitcnt lgkmcnt(0)
    ds_read_b64_tr_b16 v[144:145], v1 offset:4096
    ds_read_b64_tr_b16 v[146:147], v1 offset:5120
    ds_read_b64_tr_b16 v[148:149], v2 offset:4096
    ds_read_b64_tr_b16 v[150:151], v2 offset:5120
    ds_read_b64_tr_b16 v[152:153], v3 offset:4096
    ds_read_b64_tr_b16 v[154:155], v3 offset:5120
    ds_read_b64_tr_b16 v[156:157], v4 offset:4096
    ds_read_b64_tr_b16 v[158:159], v4 offset:5120
    s_waitcnt lgkmcnt(0)
    v_mfma_f32_32x32x16_bf16 v[192:207], v[128:131], v[64:67], v[192:207]
    v_mfma_f32_32x32x16_bf16 v[208:223], v[132:135], v[64:67], v[208:223]
    v_mfma_f32_32x32x16_bf16 v[224:239], v[136:139], v[64:67], v[224:239]
    v_mfma_f32_32x32x16_bf16 v[240:255], v[140:143], v[64:67], v[240:255]
    v_mfma_f32_32x32x16_bf16 v[192:207], v[144:147], v[68:71], v[192:207]
    v_mfma_f32_32x32x16_bf16 v[208:223], v[148:151], v[68:71], v[208:223]
    v_mfma_f32_32x32x16_bf16 v[224:239], v[152:155], v[68:71], v[224:239]
    v_mfma_f32_32x32x16_bf16 v[240:255], v[156:159], v[68:71], v[240:255]
    s_add_u32 s73, s73, 8192
    s_cmp_lt_u32 s73, 131072
    s_cbranch_scc1 K_s2
    s_mov_b32 s70, s85
    s_add_u32 m0, s69, 0
    s_add_u32 s72, s70, 8192
    buffer_load_dwordx4 v16, s[44:47], s70 offen lds
    s_add_u32 m0, s69, 1024
    s_add_u32 s70, s70, 16384
    buffer_load_dwordx4 v16, s[44:47], s72 offen lds
    s_add_u32 m0, s69, 2048
    s_add_u32 s72, s70, 8192
    buffer_load_dwordx4 v16, s[44:47], s70 offen lds
    s_add_u32 m0, s69, 3072
    s_add_u32 s70, s70, 16384
    buffer_load_dwordx4 v16, s[44:47], s72 offen lds
    s_add_u32 m0, s69, 4096
    s_add_u32 s72, s70, 8192
    buffer_load_dwordx4 v16, s[44:47], s70 offen lds
    s_add_u32 m0, s69, 5120
    s_add_u32 s70, s70, 16384
    buffer_load_dwordx4 v16, s[44:47], s72 offen lds
    s_add_u32 m0, s69, 6144
    s_add_u32 s72, s70, 8192
    buffer_load_dwordx4 v16, s[44:47], s70 offen lds
    s_add_u32 m0, s69, 7168
    s_add_u32 s70, s70, 16384
    buffer_load_dwordx4 v16, s[44:47], s72 offen lds
    s_add_u32 m0, s69, 8192
    s_add_u32 s72, s70, 8192
    buffer_load_dwordx4 v16, s[44:47], s70 offen lds
    s_add_u32 m0, s69, 9216
    s_add_u32 s70, s70, 16384
    buffer_load_dwordx4 v16, s[44:47], s72 offen lds
    s_add_u32 m0, s69, 10240
    s_add_u32 s72, s70, 8192
    buffer_load_dwordx4 v16, s[44:47], s70 offen lds
    s_add_u32 m0, s69, 11264
    s_add_u32 s70, s70, 16384
    buffer_load_dwordx4 v16, s[44:47], s72 offen lds
    v_mov_b32 v34, v30
    v_lshrrev_b32 v24, 5, v0
    v_bfe_u32 v25, v0, 2, 2
    v_bfe_u32 v26, v0, 4, 1
    v_lshlrev_b32 v26, 5, v26
    v_and_b32 v27, 1, v0
    v_lshl_add_u32 v26, v27, 4, v26
    v_bfe_u32 v27, v0, 1, 1
    v_lshl_add_u32 v26, v27, 3, v26
    v_lshl_add_u32 v27, v24, 3, v25
    v_lshl_add_u32 v27, v27, 7, v26
    v_add_u32 v27, s69, v27
    v_lshrrev_b32 v28, 1, v25
    v_lshl_add_u32 v32, v28, 6, v27
    v_xor_b32 v33, 64, v32
    s_nop 15
    v_add_f32 v22, v17, v18
    v_add_f32 v23, v19, v20
    v_add_f32 v22, v22, v23
    v_mov_b32 v23, v22
    s_nop 1
    v_permlane32_swap_b32 v22, v23
    v_add_f32 v23, v22, v23
    v_rcp_f32 v22, v23
    s_nop 0
    v_pk_mul_f32 v[192:193], v[192:193], v[22:23] op_sel_hi:[1,0]
    v_pk_mul_f32 v[194:195], v[194:195], v[22:23] op_sel_hi:[1,0]
    v_pk_mul_f32 v[196:197], v[196:197], v[22:23] op_sel_hi:[1,0]
    v_pk_mul_f32 v[198:199], v[198:199], v[22:23] op_sel_hi:[1,0]
    v_cvt_pk_bf16_f32 v96, v192, v193
    v_cvt_pk_bf16_f32 v97, v194, v195
    v_cvt_pk_bf16_f32 v98, v196, v197
    v_cvt_pk_bf16_f32 v99, v198, v199
    v_pk_mul_f32 v[200:201], v[200:201], v[22:23] op_sel_hi:[1,0]
    v_pk_mul_f32 v[202:203], v[202:203], v[22:23] op_sel_hi:[1,0]
    v_pk_mul_f32 v[204:205], v[204:205], v[22:23] op_sel_hi:[1,0]
    v_pk_mul_f32 v[206:207], v[206:207], v[22:23] op_sel_hi:[1,0]
    v_cvt_pk_bf16_f32 v100, v200, v201
    v_cvt_pk_bf16_f32 v101, v202, v203
    v_cvt_pk_bf16_f32 v102, v204, v205
    v_cvt_pk_bf16_f32 v103, v206, v207
    v_pk_mul_f32 v[208:209], v[208:209], v[22:23] op_sel_hi:[1,0]
    v_pk_mul_f32 v[210:211], v[210:211], v[22:23] op_sel_hi:[1,0]
    v_pk_mul_f32 v[212:213], v[212:213], v[22:23] op_sel_hi:[1,0]
    v_pk_mul_f32 v[214:215], v[214:215], v[22:23] op_sel_hi:[1,0]
    v_cvt_pk_bf16_f32 v104, v208, v209
    v_cvt_pk_bf16_f32 v105, v210, v211
    v_cvt_pk_bf16_f32 v106, v212, v213
    v_cvt_pk_bf16_f32 v107, v214, v215
    v_pk_mul_f32 v[216:217], v[216:217], v[22:23] op_sel_hi:[1,0]
    v_pk_mul_f32 v[218:219], v[218:219], v[22:23] op_sel_hi:[1,0]
    v_pk_mul_f32 v[220:221], v[220:221], v[22:23] op_sel_hi:[1,0]
    v_pk_mul_f32 v[222:223], v[222:223], v[22:23] op_sel_hi:[1,0]
    v_cvt_pk_bf16_f32 v108, v216, v217
    v_cvt_pk_bf16_f32 v109, v218, v219
    v_cvt_pk_bf16_f32 v110, v220, v221
    v_cvt_pk_bf16_f32 v111, v222, v223
    v_pk_mul_f32 v[224:225], v[224:225], v[22:23] op_sel_hi:[1,0]
    v_pk_mul_f32 v[226:227], v[226:227], v[22:23] op_sel_hi:[1,0]
    v_pk_mul_f32 v[228:229], v[228:229], v[22:23] op_sel_hi:[1,0]
    v_pk_mul_f32 v[230:231], v[230:231], v[22:23] op_sel_hi:[1,0]
    v_cvt_pk_bf16_f32 v112, v224, v225
    v_cvt_pk_bf16_f32 v113, v226, v227
    v_cvt_pk_bf16_f32 v114, v228, v229
    v_cvt_pk_bf16_f32 v115, v230, v231
    v_pk_mul_f32 v[232:233], v[232:233], v[22:23] op_sel_hi:[1,0]
    v_pk_mul_f32 v[234:235], v[234:235], v[22:23] op_sel_hi:[1,0]
    v_pk_mul_f32 v[236:237], v[236:237], v[22:23] op_sel_hi:[1,0]
    v_pk_mul_f32 v[238:239], v[238:239], v[22:23] op_sel_hi:[1,0]
    v_cvt_pk_bf16_f32 v116, v232, v233
    v_cvt_pk_bf16_f32 v117, v234, v235
    v_cvt_pk_bf16_f32 v118, v236, v237
    v_cvt_pk_bf16_f32 v119, v238, v239
    v_pk_mul_f32 v[240:241], v[240:241], v[22:23] op_sel_hi:[1,0]
    v_pk_mul_f32 v[242:243], v[242:243], v[22:23] op_sel_hi:[1,0]
    v_pk_mul_f32 v[244:245], v[244:245], v[22:23] op_sel_hi:[1,0]
    v_pk_mul_f32 v[246:247], v[246:247], v[22:23] op_sel_hi:[1,0]
    v_cvt_pk_bf16_f32 v120, v240, v241
    v_cvt_pk_bf16_f32 v121, v242, v243
    v_cvt_pk_bf16_f32 v122, v244, v245
    v_cvt_pk_bf16_f32 v123, v246, v247
    v_pk_mul_f32 v[248:249], v[248:249], v[22:23] op_sel_hi:[1,0]
    v_pk_mul_f32 v[250:251], v[250:251], v[22:23] op_sel_hi:[1,0]
    v_pk_mul_f32 v[252:253], v[252:253], v[22:23] op_sel_hi:[1,0]
    v_pk_mul_f32 v[254:255], v[254:255], v[22:23] op_sel_hi:[1,0]
    v_cvt_pk_bf16_f32 v124, v248, v249
    v_cvt_pk_bf16_f32 v125, v250, v251
    v_cvt_pk_bf16_f32 v126, v252, v253
    v_cvt_pk_bf16_f32 v127, v254, v255
    s_branch K_fin

.section .rodata,"a"
.p2align 6
.amdhsa_kernel adaLN_cond__sliding_block_cached__dense_activation_squared_relu__prompt_kernel
  .amdhsa_next_free_vgpr 256
  .amdhsa_next_free_sgpr 102
  .amdhsa_accum_offset 256
  .amdhsa_group_segment_fixed_size 0
  .amdhsa_kernarg_size 120
  .amdhsa_user_sgpr_count 2
  .amdhsa_user_sgpr_kernarg_segment_ptr 1
  .amdhsa_system_sgpr_workgroup_id_x 1
  .amdhsa_float_denorm_mode_32 3
  .amdhsa_float_denorm_mode_16_64 3
.end_amdhsa_kernel
```
